```python
import torch

def _softmax(x, axis=-1):
    return torch.softmax(x, dim=axis)
def _gelu(x):
    return torch.nn.functional.gelu(x, approximate="tanh")
def _silu(x):
    return torch.nn.functional.silu(x)
def _sigmoid(x):
    return torch.sigmoid(x)
def _layernorm(x, axis=-1, eps=1e-5):
    m = x.mean(dim=axis, keepdim=True)
    v = x.var(dim=axis, keepdim=True, unbiased=False)
    return (x - m) / torch.sqrt(v + eps)
def _scatter_add(tgt, idx, src, axis=0):
    return tgt.clone().index_add_(axis, idx, src)
def _segment_sum(src, seg, n):
    out = torch.zeros((n,) + src.shape[1:], dtype=src.dtype)
    return out.index_add_(0, seg, src)
def _pad(x, pw):
    flat = tuple(v for pair in reversed(pw) for v in pair)
    return torch.nn.functional.pad(x, flat)

kernel_name = 'gated_mix__ssm_conv_s4d__linear_kernel_hedgehog__prompt'

def setup_inputs():

    _w = (lambda a: (lambda t: t.to(torch.bfloat16) if t.is_floating_point() else t)(torch.as_tensor(a)))
    def _A_setup():
        Bsz, L, D, N = 1, 2048, 512, 128
        return {
            "u": _w((lambda *s: torch.randn(*s, dtype=torch.bfloat16) * 0.05)(Bsz, L, D)),
            "log_A_real": _w((lambda *s: torch.randn(*s, dtype=torch.bfloat16) * 3.2)(D, N) * 0.5),
            "A_imag": _w((lambda *s: torch.randn(*s, dtype=torch.bfloat16) * 0.05)(D, N) * 3.14),
            "C_real": _w((lambda *s: torch.randn(*s, dtype=torch.bfloat16) * 0.4)(D, N) / N ** 0.5),
            "C_imag": _w((lambda *s: torch.randn(*s, dtype=torch.bfloat16) * 0.4)(D, N) / N ** 0.5),
            "log_dt": _w((lambda *s: torch.randn(*s, dtype=torch.bfloat16) * 0.05)(D) * 0.5 - 4.0),
            "D_skip": _w((lambda *s: torch.randn(*s, dtype=torch.bfloat16) * 0.05)(D)),
        }
    _A_in = _A_setup()

    def _B_setup():
        B, S, D, H = 1, 2048, 512, 32
        Dh = D // H
        return {
            "x": _w((lambda *s: torch.randn(*s, dtype=torch.bfloat16) * 0.05)(B, S, D)),
            "wqkv": _w((lambda *s: torch.randn(*s, dtype=torch.bfloat16) * 0.8)(D, 3 * D)),
            "w_phi": _w((lambda *s: torch.randn(*s, dtype=torch.bfloat16) * 0.8)(H, Dh, Dh) * (Dh ** -0.5)),
            "wo": _w((lambda *s: torch.randn(*s, dtype=torch.bfloat16) * 0.05)(D, D)),
        }
    _B_in = _B_setup()

    return {
        "A_u": _A_in["u"],
        "A_log_A_real": _A_in["log_A_real"],
        "A_A_imag": _A_in["A_imag"],
        "A_C_real": _A_in["C_real"],
        "A_C_imag": _A_in["C_imag"],
        "A_log_dt": _A_in["log_dt"],
        "A_D_skip": _A_in["D_skip"],
        "B_x": _B_in["x"],
        "B_wqkv": _B_in["wqkv"],
        "B_w_phi": _B_in["w_phi"],
        "B_wo": _B_in["wo"],
        "gate_w": _w((lambda *s: torch.randn(*s, dtype=torch.bfloat16) * 0.05)(512) * 16.0),
    }

def reference(A_u, A_log_A_real, A_A_imag, A_C_real, A_C_imag, A_log_dt, A_D_skip, B_x, B_wqkv, B_w_phi, B_wo, gate_w):
    def _A_ref(u, log_A_real, A_imag, C_real, C_imag, log_dt, D_skip):
        L = u.shape[1]
        dt = torch.exp(log_dt)
        A = -torch.exp(log_A_real) + 1j * A_imag
        C = (C_real + 1j * C_imag) * dt[:, None]
        pos = (lambda x, dt: x.to(dt))(torch.arange(L), log_dt.dtype)
        P = torch.exp((A * dt[:, None])[:, :, None] * pos[None, None, :])
        K = 2.0 * torch.einsum("dn,dnl->dl", C, P).real
        L2 = 2 * L
        u_t = (lambda x, *d: x.permute(*d))(u, 0, 2, 1)
        Kf = (lambda x, *a, **k: torch.fft.rfft(x.float(), *a, **k))(K, L2)
        Uf = (lambda x, *a, **k: torch.fft.rfft(x.float(), *a, **k))(u_t, L2)
        y = (lambda x, *a, **k: torch.fft.irfft(x, *a, **k).to(torch.bfloat16))(Uf * Kf[None, :, :], L2)[:, :, :L]
        y = (lambda x, *d: x.permute(*d))(y, 0, 2, 1)
        return y + u * D_skip[None, None, :]

    def _B_ref(x, wqkv, w_phi, wo):
        B, S, D = x.shape
        H = 32; Dh = D // H
        qkv = (lambda x, *d: x.permute(*d))((x @ wqkv).reshape(B, S, 3, H, Dh), 2, 0, 3, 1, 4)
        q, k, v = qkv[0], qkv[1], qkv[2]
        pq = torch.einsum("bhsd,hdf->bhsf", q, w_phi)
        pk = torch.einsum("bhsd,hdf->bhsf", k, w_phi)
        phi_q = torch.concatenate([_softmax(pq, axis=-1), _softmax(-pq, axis=-1)], axis=-1)
        phi_k = torch.concatenate([_softmax(pk, axis=-1), _softmax(-pk, axis=-1)], axis=-1)
        kv = torch.einsum("bhsf,bhsd->bhfd", phi_k, v)
        z  = torch.einsum("bhsf->bhf", phi_k)
        num = torch.einsum("bhqf,bhfd->bhqd", phi_q, kv)
        den = torch.einsum("bhqf,bhf->bhq", phi_q, z)[..., None] + 1e-6
        o = num / den
        return (lambda x, *d: x.permute(*d))(o, 0, 2, 1, 3).reshape(B, S, D) @ wo

    x = A_u
    g = _sigmoid((x * gate_w).sum(-1, keepdims=True))
    a = _A_ref(x, A_log_A_real, A_A_imag, A_C_real, A_C_imag, A_log_dt, A_D_skip)
    b = _B_ref(x, B_wqkv, B_w_phi, B_wo)
    return g * a + (1 - g) * b
```

```asm
; @launch grid=(256,1,1) block=(512,1,1) lds=163840
.amdgcn_target "amdgcn-amd-amdhsa--gfx950"
.text
.globl gated_mix__ssm_conv_s4d__linear_kernel_hedgehog__prompt_kernel
.p2align 12
.p2align 8
.type gated_mix__ssm_conv_s4d__linear_kernel_hedgehog__prompt_kernel,@function
gated_mix__ssm_conv_s4d__linear_kernel_hedgehog__prompt_kernel:
s_cmp_ge_u32 s2, 256
s_cbranch_scc1 K_END
v_lshrrev_b32 v1, 6, v0
v_and_b32 v0, 63, v0
v_readfirstlane_b32 s26, v1
s_cmp_ge_u32 s26, 4
s_cbranch_scc0 K_B
s_setprio 3
s_load_dwordx4 s[4:7], s[0:1], 8
s_load_dwordx4 s[8:11], s[0:1], 24
s_load_dwordx4 s[16:19], s[0:1], 40
s_load_dwordx2 s[12:13], s[0:1], 112
s_getpc_b64 s[40:41]
K_PC:
s_bfe_u32 s42, s2, 0x30003
s_lshl_b32 s42, s42, 2
s_add_u32 s42, s42, s26
s_mul_i32 s42, s42, 768
s_sub_u32 s42, s42, 3072
v_lshlrev_b32 v3, 7, v0
v_add_u32 v3, s42, v3
v_min_u32 v3, K_LAST-K_PC, v3
s_mov_b64 exec, 0x3f
global_load_dword v120, v3, s[40:41]
s_mov_b64 exec, -1
s_and_b32 s27, s2, 7
s_lshr_b32 s28, s2, 3
s_lshr_b32 s24, s27, 1
s_lshl_b32 s24, s24, 2
s_lshr_b32 s25, s28, 3
s_add_u32 s24, s24, s25
s_and_b32 s25, s27, 1
s_lshl_b32 s25, s25, 3
s_and_b32 s28, s28, 7
s_add_u32 s25, s25, s28
s_lshl_b32 s50, s24, 4
s_add_u32 s50, s50, s25
s_lshl_b32 s29, s24, 1
s_add_u32 s29, s29, s25
s_and_b32 s29, s29, 7
s_lshl_b32 s27, s26, 7
s_add_u32 s27, s27, 116736
v_and_b32 v8, 31, v0
v_lshlrev_b32 v8, 2, v8
v_add_u32 v8, s27, v8
v_mov_b32 v9, 0
ds_write_b32 v8, v9
ds_write_b32 v8, v9 offset:512
v_mov_b32 v56, v8
s_sub_u32 s26, s26, 4
s_mov_b32 s14, 268435456
s_mov_b32 s15, 0x00020000
s_lshl_b32 s27, s50, 9
s_lshl_b32 s28, s26, 7
s_add_u32 s27, s27, s28
v_lshlrev_b32 v1, 1, v0
v_add_u32 v1, s27, v1
v_mov_b32 v8, 0
v_mov_b32 v9, 0
v_mov_b32 v10, 0
v_mov_b32 v11, 0
s_lshl_b32 s28, s26, 8
s_add_u32 s28, s28, 154624
v_and_b32 v7, 15, v0
v_lshlrev_b32 v7, 4, v7
v_add_u32 v7, s28, v7
ds_write_b128 v7, v[8:11]
s_lshl_b32 s28, s50, 2
s_mov_b32 s60, 11665408
s_mov_b32 s61, s28
s_waitcnt lgkmcnt(0)
global_load_ushort v2, v1, s[4:5]
global_load_ushort v3, v1, s[6:7]
global_load_ushort v4, v1, s[8:9]
global_load_ushort v5, v1, s[10:11]
s_load_dword s20, s[16:17], s61
s_load_dword s21, s[18:19], s61
buffer_load_dword v62, v8, s[12:15], s60 offen sc1
s_setprio 0
s_branch K_A
K_B:
s_setprio 2
s_load_dwordx2 s[4:5], s[0:1], 0
s_load_dwordx2 s[8:9], s[0:1], 64
s_load_dwordx2 s[16:17], s[0:1], 72
s_load_dwordx2 s[20:21], s[0:1], 88
s_load_dwordx2 s[12:13], s[0:1], 112
s_load_dwordx2 s[40:41], s[0:1], 80
s_load_dwordx2 s[44:45], s[0:1], 96
s_and_b32 s27, s2, 7
s_lshr_b32 s28, s2, 3
s_lshr_b32 s24, s27, 1
s_lshl_b32 s24, s24, 2
s_lshr_b32 s25, s28, 3
s_add_u32 s24, s24, s25
s_and_b32 s25, s27, 1
s_lshl_b32 s25, s25, 3
s_and_b32 s28, s28, 7
s_add_u32 s25, s25, s28
s_lshl_b32 s50, s24, 4
s_add_u32 s50, s50, s25
s_lshl_b32 s29, s24, 1
s_add_u32 s29, s29, s25
s_and_b32 s29, s29, 7
s_lshl_b32 s27, s26, 7
s_add_u32 s27, s27, 116736
v_and_b32 v8, 31, v0
v_lshlrev_b32 v8, 2, v8
v_add_u32 v8, s27, v8
v_mov_b32 v9, 0
ds_write_b32 v8, v9
ds_write_b32 v8, v9 offset:512
s_mov_b32 s6, 2097152
s_mov_b32 s7, 0x00020000
s_mov_b32 s10, 1572864
s_mov_b32 s11, 0x00020000
s_mov_b32 s14, 268435456
s_mov_b32 s15, 0x00020000
s_mov_b32 s18, 16384
s_mov_b32 s19, 0x00020000
s_mov_b32 s22, 1024
s_mov_b32 s23, 0x00020000
s_mov_b32 s42, 524288
s_mov_b32 s43, 0x00020000
s_mov_b32 s46, 2097152
s_mov_b32 s47, 0x00020000
s_mov_b32 s32, 1069066811
s_mov_b32 s33, 1069066811
s_mov_b32 s49, 0
v_lshrrev_b32 v20, 3, v0
v_and_b32 v21, 7, v0
v_lshrrev_b32 v22, 4, v0
v_xor_b32 v23, v21, v22
v_lshlrev_b32 v23, 4, v23
v_lshl_add_u32 v23, v20, 10, v23
s_lshl_b32 s27, s24, 17
s_lshl_b32 s28, s26, 15
s_add_u32 s27, s27, s28
v_add_u32 v72, s27, v23
v_xor_b32 v73, 64, v72
v_add_u32 v73, 0x1c00, v73
v_add_u32 v74, 0x3800, v72
v_add_u32 v75, 0x3800, v73
v_lshrrev_b32 v20, 2, v0
v_and_b32 v21, 3, v0
v_lshlrev_b32 v21, 4, v21
s_mul_i32 s27, s26, 49152
s_lshl_b32 s28, s25, 6
s_add_u32 s27, s27, s28
s_add_u32 s27, s27, 1024
v_mul_u32_u24 v20, 0xc00, v20
v_add3_u32 v16, v20, v21, s27
v_lshlrev_b32 v17, 4, v0
s_lshl_b32 s31, s26, 12
s_lshl_b32 s30, s29, 7
v_and_b32 v21, 1, v0
v_bfe_u32 v22, v0, 4, 1
v_cmp_eq_u32 vcc, v21, v22
v_lshrrev_b32 v20, 5, v0
v_lshlrev_b32 v20, 4, v20
v_add_u32 v20, s30, v20
v_mov_b32 v21, 0x1000
v_cndmask_b32 v20, v21, v20, vcc
s_lshl_b32 s28, s25, 10
s_waitcnt lgkmcnt(0)
s_add_u32 m0, s31, 32768
s_nop 0
buffer_load_dwordx4 v72, s[4:7], s30 offen offset:0 lds
buffer_load_dwordx4 v73, s[4:7], s30 offen offset:1024 lds
buffer_load_dwordx4 v74, s[4:7], s30 offen offset:2048 lds
buffer_load_dwordx4 v75, s[4:7], s30 offen offset:3072 lds
s_cmp_eq_u32 s26, 0
s_cbranch_scc0 BP_1
s_mov_b32 m0, 114688
s_nop 0
buffer_load_dwordx4 v17, s[16:19], s28 offen lds
BP_1:
buffer_load_dwordx4 v[84:87], v20, s[20:23], 0 offen offset:0
buffer_load_dwordx4 v[88:91], v20, s[20:23], 0 offen offset:32
buffer_load_dwordx4 v[92:95], v20, s[20:23], 0 offen offset:64
buffer_load_dwordx4 v[96:99], v20, s[20:23], 0 offen offset:96
s_add_u32 s27, s29, 0
s_and_b32 s27, s27, 7
s_mul_i32 s16, s27, 196608
s_add_u32 m0, s31, 0
s_nop 0
buffer_load_dwordx4 v16, s[8:11], s16 offen lds
s_add_u32 s27, s29, 1
s_and_b32 s27, s27, 7
s_mul_i32 s17, s27, 196608
s_add_u32 m0, s31, 1024
s_nop 0
buffer_load_dwordx4 v16, s[8:11], s17 offen lds
s_add_u32 s27, s29, 2
s_and_b32 s27, s27, 7
s_mul_i32 s18, s27, 196608
s_add_u32 m0, s31, 2048
s_nop 0
buffer_load_dwordx4 v16, s[8:11], s18 offen lds
s_add_u32 s27, s29, 3
s_and_b32 s27, s27, 7
s_mul_i32 s19, s27, 196608
s_add_u32 m0, s31, 3072
s_nop 0
buffer_load_dwordx4 v16, s[8:11], s19 offen lds
s_add_u32 s27, s29, 4
s_and_b32 s27, s27, 7
s_mul_i32 s20, s27, 196608
s_add_u32 s27, s29, 5
s_and_b32 s27, s27, 7
s_mul_i32 s21, s27, 196608
s_add_u32 s27, s29, 6
s_and_b32 s27, s27, 7
s_mul_i32 s22, s27, 196608
s_add_u32 s27, s29, 7
s_and_b32 s27, s27, 7
s_mul_i32 s23, s27, 196608
v_and_b32 v20, 31, v0
v_lshrrev_b32 v21, 5, v0
v_bfe_u32 v22, v0, 1, 3
v_xor_b32 v22, v22, v21
v_lshlrev_b32 v22, 4, v22
v_lshl_add_u32 v22, v20, 7, v22
s_add_u32 s27, s31, 32768
v_add_u32 v2, s27, v22
v_xor_b32 v3, 32, v2
v_xor_b32 v4, 64, v2
v_xor_b32 v5, 96, v2
v_bfe_u32 v22, v0, 2, 2
v_bfe_u32 v23, v0, 4, 1
v_and_b32 v24, 3, v0
v_lshlrev_b32 v24, 3, v24
v_lshl_add_u32 v24, v23, 5, v24
v_lshl_add_u32 v24, v22, 6, v24
v_lshl_add_u32 v6, v21, 9, v24
v_add_u32 v7, 0x10000, v6
v_and_b32 v24, 1, v0
v_lshrrev_b32 v25, 4, v0
v_lshlrev_b32 v25, 7, v25
v_lshl_add_u32 v25, v20, 2, v25
v_add_u32 v9, 116736, v25
v_bfe_u32 v26, v0, 2, 1
v_cmp_eq_u32 vcc, v26, v21
v_lshlrev_b32 v27, 4, v24
v_mov_b32 v28, 0x3f80
v_lshlrev_b32 v28, v27, v28
v_cndmask_b32 v28, 0, v28, vcc
v_bfe_u32 v27, v0, 3, 2
v_bfe_u32 v29, v0, 1, 1
v_lshl_add_u32 v30, v27, 1, v29
v_cmp_eq_u32 vcc, 0, v30
s_nop 1
v_cndmask_b32 v124, 0, v28, vcc
v_cmp_eq_u32 vcc, 1, v30
s_nop 1
v_cndmask_b32 v125, 0, v28, vcc
v_cmp_eq_u32 vcc, 2, v30
s_nop 1
v_cndmask_b32 v126, 0, v28, vcc
v_cmp_eq_u32 vcc, 3, v30
s_nop 1
v_cndmask_b32 v127, 0, v28, vcc
v_cmp_eq_u32 vcc, 4, v30
s_nop 1
v_cndmask_b32 v76, 0, v28, vcc
v_cmp_eq_u32 vcc, 5, v30
s_nop 1
v_cndmask_b32 v77, 0, v28, vcc
v_cmp_eq_u32 vcc, 6, v30
s_nop 1
v_cndmask_b32 v78, 0, v28, vcc
v_cmp_eq_u32 vcc, 7, v30
s_nop 1
v_cndmask_b32 v79, 0, v28, vcc
v_lshlrev_b32 v80, 31, v26
v_lshrrev_b32 v81, 16, v80
v_or_b32 v80, v80, v81
v_lshlrev_b32 v26, 6, v26
v_lshl_add_u32 v26, v27, 4, v26
v_and_b32 v28, 3, v0
v_lshl_add_u32 v26, v28, 2, v26
v_lshl_add_u32 v26, v21, 7, v26
s_add_u32 s27, s31, 16384
v_add_u32 v14, s27, v26
v_lshl_add_u32 v26, v21, 2, v22
v_lshlrev_b32 v26, 5, v26
v_lshl_add_u32 v26, v23, 4, v26
v_lshl_add_u32 v26, v29, 3, v26
v_add_u32 v81, 114688, v26
s_lshl_b32 s34, s24, 17
s_lshl_b32 s27, s26, 15
s_add_u32 s34, s34, s27
s_lshl_b32 s27, s25, 11
s_add_u32 s34, s34, s27
s_add_u32 s34, s34, 2097152
s_cmp_eq_u32 s26, 0
s_cselect_b32 s35, 0xff, 0
s_mov_b32 s36, 0x358637bd
s_lshl_b32 s52, s25, 15
s_lshl_b32 s27, s26, 13
s_add_u32 s52, s52, s27
s_add_u32 s52, s52, 6291456
s_add_u32 s53, s52, 4096
s_lshl_b32 s54, s25, 13
s_lshl_b32 s27, s26, 11
s_add_u32 s54, s54, s27
s_add_u32 s54, s54, 6815744
s_lshr_b32 s55, s52, 2
s_add_u32 s55, s55, 12582912
s_lshr_b32 s38, s54, 2
s_add_u32 s38, s38, 12582912
s_lshr_b32 s39, s34, 2
s_add_u32 s39, s39, 12582912
s_mov_b32 s62, 12582912
s_lshl_b32 s3, s24, 1
s_lshr_b32 s27, s25, 3
s_add_u32 s3, s3, s27
s_lshl_b32 s3, s3, 2
s_add_u32 s3, s3, s26
s_lshl_b32 s3, s3, 11
s_add_u32 s3, s3, 7340032
s_and_b32 s27, s25, 7
s_lshl_b32 s27, s27, 2
s_add_u32 s0, s3, s27
s_lshl_b32 s56, s24, 17
s_lshr_b32 s27, s25, 3
s_lshl_b32 s27, s27, 16
s_add_u32 s56, s56, s27
s_and_b32 s27, s25, 7
s_lshl_b32 s27, s27, 7
s_add_u32 s60, s56, s27
s_lshr_b32 s27, s26, 1
s_lshl_b32 s27, s27, 15
s_add_u32 s60, s60, s27
s_and_b32 s27, s26, 1
s_lshl_b32 s27, s27, 6
s_add_u32 s30, s30, 128
s_and_b32 s30, s30, 0x3ff
s_add_u32 m0, s31, 49152
s_nop 0
buffer_load_dwordx4 v72, s[4:7], s30 offen offset:0 lds
s_add_u32 s60, s60, s27
s_lshl_b32 s27, s26, 14
buffer_load_dwordx4 v73, s[4:7], s30 offen offset:1024 lds
s_add_u32 s56, s56, s27
s_add_u32 s56, s56, 2097152
buffer_load_dwordx4 v74, s[4:7], s30 offen offset:2048 lds
s_add_u32 s57, s56, 4096
s_add_u32 s58, s56, 8192
buffer_load_dwordx4 v75, s[4:7], s30 offen offset:3072 lds
s_add_u32 s59, s56, 12288
s_lshr_b32 s61, s56, 2
s_add_u32 s61, s61, 12582912
s_waitcnt vmcnt(12)
ds_read_b128 v[128:131], v2 offset:0
ds_read_b128 v[132:135], v3 offset:0
ds_read_b128 v[136:139], v4 offset:0
ds_read_b128 v[140:143], v5 offset:0
v_add_u32 v2, 0x4000, v2
v_add_u32 v3, 0x4000, v3
v_add_u32 v4, 0x4000, v4
v_add_u32 v5, 0x4000, v5
s_barrier
s_add_u32 m0, s31, 16384
s_nop 0
buffer_load_dwordx4 v16, s[8:11], s20 offen lds
s_add_u32 m0, s31, 17408
s_nop 0
buffer_load_dwordx4 v16, s[8:11], s21 offen lds
s_add_u32 m0, s31, 18432
s_nop 0
buffer_load_dwordx4 v16, s[8:11], s22 offen lds
s_add_u32 m0, s31, 19456
s_nop 0
buffer_load_dwordx4 v16, s[8:11], s23 offen lds
s_waitcnt vmcnt(8)
v_mov_b32 v18, 2
ds_write_b32 v8, v18
ds_read_b32 v19, v9 offset:0
s_add_u32 s30, s30, 128
s_and_b32 s30, s30, 0x3ff
s_add_u32 m0, s31, 65536
s_nop 0
buffer_load_dwordx4 v72, s[4:7], s30 offen offset:0 lds
buffer_load_dwordx4 v73, s[4:7], s30 offen offset:1024 lds
buffer_load_dwordx4 v74, s[4:7], s30 offen offset:2048 lds
buffer_load_dwordx4 v75, s[4:7], s30 offen offset:3072 lds
s_waitcnt lgkmcnt(5)
v_mfma_f32_16x16x32_bf16 v[68:71], v[84:87], v[128:131], 0
s_waitcnt lgkmcnt(4)
v_mfma_f32_16x16x32_bf16 v[68:71], v[88:91], v[132:135], v[68:71]
s_waitcnt lgkmcnt(3)
v_mfma_f32_16x16x32_bf16 v[68:71], v[92:95], v[136:139], v[68:71]
s_waitcnt lgkmcnt(2)
v_mfma_f32_16x16x32_bf16 v[68:71], v[96:99], v[140:143], v[68:71]
BS_3:
s_waitcnt lgkmcnt(0)
v_cmp_gt_u32 vcc, 2, v19
s_cbranch_vccz BD_4
ds_read_b32 v19, v9 offset:0
s_add_u32 s49, s49, 1
s_cmp_lt_u32 s49, 131072
s_cbranch_scc1 BS_3
BD_4:
ds_read_b64_tr_b16 v[20:21], v6 offset:0
ds_read_b64_tr_b16 v[22:23], v6 offset:256
ds_read_b64_tr_b16 v[24:25], v6 offset:4096
ds_read_b64_tr_b16 v[26:27], v6 offset:4352
ds_read_b64_tr_b16 v[28:29], v6 offset:8192
ds_read_b64_tr_b16 v[30:31], v6 offset:8448
ds_read_b64_tr_b16 v[32:33], v6 offset:12288
ds_read_b64_tr_b16 v[34:35], v6 offset:12544
ds_read_b64_tr_b16 v[36:37], v6 offset:1024
ds_read_b64_tr_b16 v[38:39], v6 offset:1280
ds_read_b64_tr_b16 v[40:41], v6 offset:5120
ds_read_b64_tr_b16 v[42:43], v6 offset:5376
ds_read_b64_tr_b16 v[44:45], v6 offset:9216
ds_read_b64_tr_b16 v[46:47], v6 offset:9472
ds_read_b64_tr_b16 v[48:49], v6 offset:13312
ds_read_b64_tr_b16 v[50:51], v6 offset:13568
ds_read_b64_tr_b16 v[116:117], v81 offset:0
ds_read_b64_tr_b16 v[118:119], v81 offset:256
ds_read_b64_tr_b16 v[120:121], v81 offset:512
ds_read_b64_tr_b16 v[122:123], v81 offset:768
s_add_u32 s30, s30, 128
s_and_b32 s30, s30, 0x3ff
s_add_u32 m0, s31, 81920
s_nop 0
buffer_load_dwordx4 v72, s[4:7], s30 offen offset:0 lds
buffer_load_dwordx4 v73, s[4:7], s30 offen offset:1024 lds
buffer_load_dwordx4 v74, s[4:7], s30 offen offset:2048 lds
buffer_load_dwordx4 v75, s[4:7], s30 offen offset:3072 lds
s_waitcnt vmcnt(12)
ds_read_b128 v[144:147], v2 offset:0
ds_read_b128 v[148:151], v3 offset:0
ds_read_b128 v[152:155], v4 offset:0
ds_read_b128 v[156:159], v5 offset:0
s_mov_b32 vcc_lo, 0xffff0000
s_mov_b32 vcc_hi, 0xffff0000
v_cndmask_b32 v1, v68, v69, vcc
s_waitcnt lgkmcnt(15)
v_mfma_f32_32x32x16_bf16 v[52:67], v[20:23], v[128:131], 0
ds_read_b64_tr_b16 v[20:21], v6 offset:2048
ds_read_b64_tr_b16 v[22:23], v6 offset:2304
s_add_u32 s30, s30, 128
s_and_b32 s30, s30, 0x3ff
s_add_u32 m0, s31, 98304
s_nop 0
buffer_load_dwordx4 v72, s[4:7], s30 offen offset:0 lds
v_mfma_f32_32x32x16_bf16 v[52:67], v[24:27], v[132:135], v[52:67]
ds_read_b64_tr_b16 v[24:25], v6 offset:6144
ds_read_b64_tr_b16 v[26:27], v6 offset:6400
buffer_load_dwordx4 v73, s[4:7], s30 offen offset:1024 lds
v_mfma_f32_32x32x16_bf16 v[52:67], v[28:31], v[136:139], v[52:67]
ds_read_b64_tr_b16 v[28:29], v6 offset:10240
ds_read_b64_tr_b16 v[30:31], v6 offset:10496
buffer_load_dwordx4 v74, s[4:7], s30 offen offset:2048 lds
v_mfma_f32_32x32x16_bf16 v[52:67], v[32:35], v[140:143], v[52:67]
ds_read_b64_tr_b16 v[32:33], v6 offset:14336
ds_read_b64_tr_b16 v[34:35], v6 offset:14592
buffer_load_dwordx4 v75, s[4:7], s30 offen offset:3072 lds
s_waitcnt lgkmcnt(15)
s_waitcnt lgkmcnt(11)
v_mfma_f32_32x32x16_bf16 v[52:67], v[36:39], v[144:147], v[52:67]
ds_read_b64_tr_b16 v[36:37], v6 offset:3072
ds_read_b64_tr_b16 v[38:39], v6 offset:3328
s_waitcnt lgkmcnt(12)
v_mfma_f32_32x32x16_bf16 v[52:67], v[40:43], v[148:151], v[52:67]
ds_read_b64_tr_b16 v[40:41], v6 offset:7168
ds_read_b64_tr_b16 v[42:43], v6 offset:7424
s_waitcnt lgkmcnt(13)
v_mfma_f32_32x32x16_bf16 v[52:67], v[44:47], v[152:155], v[52:67]
ds_read_b64_tr_b16 v[44:45], v6 offset:11264
ds_read_b64_tr_b16 v[46:47], v6 offset:11520
s_waitcnt lgkmcnt(14)
v_mfma_f32_32x32x16_bf16 v[52:67], v[48:51], v[156:159], v[52:67]
ds_read_b64_tr_b16 v[48:49], v6 offset:15360
ds_read_b64_tr_b16 v[50:51], v6 offset:15616
s_add_u32 s30, s30, 128
s_and_b32 s30, s30, 0x3ff
s_add_u32 m0, s31, 49152
s_nop 0
buffer_load_dwordx4 v72, s[4:7], s30 offen offset:0 lds
buffer_load_dwordx4 v73, s[4:7], s30 offen offset:1024 lds
buffer_load_dwordx4 v74, s[4:7], s30 offen offset:2048 lds
buffer_load_dwordx4 v75, s[4:7], s30 offen offset:3072 lds
s_waitcnt vmcnt(12)
ds_read_b128 v[160:163], v2 offset:16384
ds_read_b128 v[164:167], v3 offset:16384
ds_read_b128 v[168:171], v4 offset:16384
ds_read_b128 v[172:175], v5 offset:16384
v_mov_b32 v18, 3
ds_write_b32 v8, v18
ds_read_b32 v19, v9 offset:0
BS_5:
s_waitcnt lgkmcnt(0)
v_cmp_gt_u32 vcc, 3, v19
s_cbranch_vccz BD_6
ds_read_b32 v19, v9 offset:0
s_add_u32 s49, s49, 1
s_cmp_lt_u32 s49, 131072
s_cbranch_scc1 BS_5
BD_6:
v_mfma_f32_32x32x16_bf16 v[52:67], v[20:23], v[160:163], v[52:67]
ds_read_b64_tr_b16 v[20:21], v6 offset:16384
ds_read_b64_tr_b16 v[22:23], v6 offset:16640
v_xor_b32 v116, v80, v116
v_xor_b32 v117, v80, v117
v_mfma_f32_32x32x16_bf16 v[52:67], v[24:27], v[164:167], v[52:67]
ds_read_b64_tr_b16 v[24:25], v6 offset:20480
ds_read_b64_tr_b16 v[26:27], v6 offset:20736
v_xor_b32 v118, v80, v118
v_xor_b32 v119, v80, v119
v_mfma_f32_32x32x16_bf16 v[52:67], v[28:31], v[168:171], v[52:67]
ds_read_b64_tr_b16 v[28:29], v6 offset:24576
ds_read_b64_tr_b16 v[30:31], v6 offset:24832
v_xor_b32 v120, v80, v120
v_xor_b32 v121, v80, v121
v_mfma_f32_32x32x16_bf16 v[52:67], v[32:35], v[172:175], v[52:67]
ds_read_b64_tr_b16 v[32:33], v6 offset:28672
ds_read_b64_tr_b16 v[34:35], v6 offset:28928
v_xor_b32 v122, v80, v122
v_xor_b32 v123, v80, v123
s_add_u32 s30, s30, 128
s_and_b32 s30, s30, 0x3ff
s_add_u32 m0, s31, 65536
s_nop 0
buffer_load_dwordx4 v72, s[4:7], s30 offen offset:0 lds
buffer_load_dwordx4 v73, s[4:7], s30 offen offset:1024 lds
buffer_load_dwordx4 v74, s[4:7], s30 offen offset:2048 lds
buffer_load_dwordx4 v75, s[4:7], s30 offen offset:3072 lds
s_waitcnt vmcnt(12)
ds_read_b128 v[176:179], v2 offset:32768
ds_read_b128 v[180:183], v3 offset:32768
ds_read_b128 v[184:187], v4 offset:32768
ds_read_b128 v[188:191], v5 offset:32768
s_waitcnt lgkmcnt(3)
v_mfma_f32_32x32x16_bf16 v[52:67], v[36:39], v[176:179], v[52:67]
ds_read_b64_tr_b16 v[36:37], v6 offset:17408
ds_read_b64_tr_b16 v[38:39], v6 offset:17664
s_waitcnt lgkmcnt(4)
v_mfma_f32_32x32x16_bf16 v[52:67], v[40:43], v[180:183], v[52:67]
ds_read_b64_tr_b16 v[40:41], v6 offset:21504
ds_read_b64_tr_b16 v[42:43], v6 offset:21760
s_waitcnt lgkmcnt(5)
v_mfma_f32_32x32x16_bf16 v[52:67], v[44:47], v[184:187], v[52:67]
ds_read_b64_tr_b16 v[44:45], v6 offset:25600
ds_read_b64_tr_b16 v[46:47], v6 offset:25856
s_waitcnt lgkmcnt(6)
v_mfma_f32_32x32x16_bf16 v[52:67], v[48:51], v[188:191], v[52:67]
ds_read_b64_tr_b16 v[48:49], v6 offset:29696
ds_read_b64_tr_b16 v[50:51], v6 offset:29952
s_add_u32 s30, s30, 128
s_and_b32 s30, s30, 0x3ff
s_add_u32 m0, s31, 81920
s_nop 0
buffer_load_dwordx4 v72, s[4:7], s30 offen offset:0 lds
buffer_load_dwordx4 v73, s[4:7], s30 offen offset:1024 lds
buffer_load_dwordx4 v74, s[4:7], s30 offen offset:2048 lds
buffer_load_dwordx4 v75, s[4:7], s30 offen offset:3072 lds
ds_read_b32 v19, v9 offset:512
s_waitcnt vmcnt(12)
ds_read_b128 v[192:195], v2 offset:49152
ds_read_b128 v[196:199], v3 offset:49152
ds_read_b128 v[200:203], v4 offset:49152
ds_read_b128 v[204:207], v5 offset:49152
s_waitcnt lgkmcnt(4)
v_cmp_gt_u32 vcc, 1, v19
s_cbranch_vccz BD_8
ds_read_b32 v19, v9 offset:512
BS_7:
s_waitcnt lgkmcnt(0)
v_cmp_gt_u32 vcc, 1, v19
s_cbranch_vccz BD_8
ds_read_b32 v19, v9 offset:512
s_add_u32 s49, s49, 1
s_cmp_lt_u32 s49, 131072
s_cbranch_scc1 BS_7
BD_8:
v_mov_b32 v10, 118784
ds_read_b32 v10, v10
s_waitcnt lgkmcnt(15)
s_waitcnt lgkmcnt(4)
v_mfma_f32_32x32x16_bf16 v[52:67], v[20:23], v[192:195], v[52:67]
ds_read_b64_tr_b16 v[20:21], v6 offset:18432
ds_read_b64_tr_b16 v[22:23], v6 offset:18688
v_add_u32 v16, 1024, v16
s_add_u32 m0, s31, 32768
s_nop 0
buffer_load_dwordx4 v16, s[8:11], s16 offen lds
s_waitcnt lgkmcnt(5)
v_mfma_f32_32x32x16_bf16 v[52:67], v[24:27], v[196:199], v[52:67]
ds_read_b64_tr_b16 v[24:25], v6 offset:22528
ds_read_b64_tr_b16 v[26:27], v6 offset:22784
s_add_u32 m0, s31, 33792
s_nop 0
buffer_load_dwordx4 v16, s[8:11], s17 offen lds
s_waitcnt lgkmcnt(6)
v_mfma_f32_32x32x16_bf16 v[52:67], v[28:31], v[200:203], v[52:67]
ds_read_b64_tr_b16 v[28:29], v6 offset:26624
ds_read_b64_tr_b16 v[30:31], v6 offset:26880
s_waitcnt lgkmcnt(7)
v_mfma_f32_32x32x16_bf16 v[52:67], v[32:35], v[204:207], v[52:67]
ds_read_b64_tr_b16 v[32:33], v6 offset:30720
ds_read_b64_tr_b16 v[34:35], v6 offset:30976
s_waitcnt lgkmcnt(8)
v_readfirstlane_b32 s48, v10
v_lshlrev_b32 v10, 5, v0
s_mov_b32 exec_lo, 0
v_add_u32 v1, s48, v1
s_mov_b32 exec_lo, -1
buffer_store_dword v1, v10, s[12:15], s0 offen sc1
s_waitcnt vmcnt(11)
ds_read_b128 v[208:211], v2 offset:0
ds_read_b128 v[212:215], v3 offset:0
ds_read_b128 v[216:219], v4 offset:0
ds_read_b128 v[220:223], v5 offset:0
s_waitcnt lgkmcnt(15)
s_waitcnt lgkmcnt(3)
v_mfma_f32_32x32x16_bf16 v[52:67], v[36:39], v[208:211], v[52:67]
ds_read_b64_tr_b16 v[36:37], v6 offset:19456
ds_read_b64_tr_b16 v[38:39], v6 offset:19712
s_add_u32 m0, s31, 34816
s_nop 0
buffer_load_dwordx4 v16, s[8:11], s18 offen lds
s_waitcnt lgkmcnt(4)
v_mfma_f32_32x32x16_bf16 v[52:67], v[40:43], v[212:215], v[52:67]
ds_read_b64_tr_b16 v[40:41], v6 offset:23552
ds_read_b64_tr_b16 v[42:43], v6 offset:23808
s_add_u32 m0, s31, 35840
s_nop 0
buffer_load_dwordx4 v16, s[8:11], s19 offen lds
s_waitcnt lgkmcnt(5)
v_mfma_f32_32x32x16_bf16 v[52:67], v[44:47], v[216:219], v[52:67]
ds_read_b64_tr_b16 v[44:45], v6 offset:27648
ds_read_b64_tr_b16 v[46:47], v6 offset:27904
s_waitcnt lgkmcnt(6)
v_mfma_f32_32x32x16_bf16 v[52:67], v[48:51], v[220:223], v[52:67]
ds_read_b64_tr_b16 v[48:49], v6 offset:31744
ds_read_b64_tr_b16 v[50:51], v6 offset:32000
s_waitcnt vmcnt(9)
ds_read_b128 v[224:227], v2 offset:16384
ds_read_b128 v[228:231], v3 offset:16384
ds_read_b128 v[232:235], v4 offset:16384
ds_read_b128 v[236:239], v5 offset:16384
s_waitcnt lgkmcnt(15)
s_waitcnt lgkmcnt(3)
v_mfma_f32_32x32x16_bf16 v[52:67], v[20:23], v[224:227], v[52:67]
s_add_u32 m0, s31, 98304
s_nop 0
buffer_load_dwordx4 v16, s[8:11], s20 offen lds
s_waitcnt lgkmcnt(2)
v_mfma_f32_32x32x16_bf16 v[52:67], v[24:27], v[228:231], v[52:67]
s_add_u32 m0, s31, 99328
s_nop 0
buffer_load_dwordx4 v16, s[8:11], s21 offen lds
s_waitcnt lgkmcnt(1)
v_mfma_f32_32x32x16_bf16 v[52:67], v[28:31], v[232:235], v[52:67]
s_waitcnt lgkmcnt(0)
v_mfma_f32_32x32x16_bf16 v[52:67], v[32:35], v[236:239], v[52:67]
s_waitcnt vmcnt(7)
ds_read_b128 v[240:243], v2 offset:32768
ds_read_b128 v[244:247], v3 offset:32768
ds_read_b128 v[248:251], v4 offset:32768
ds_read_b128 v[252:255], v5 offset:32768
s_waitcnt lgkmcnt(3)
v_mfma_f32_32x32x16_bf16 v[52:67], v[36:39], v[240:243], v[52:67]
s_add_u32 m0, s31, 100352
s_nop 0
buffer_load_dwordx4 v16, s[8:11], s22 offen lds
s_waitcnt lgkmcnt(2)
v_mfma_f32_32x32x16_bf16 v[52:67], v[40:43], v[244:247], v[52:67]
s_add_u32 m0, s31, 101376
s_nop 0
buffer_load_dwordx4 v16, s[8:11], s23 offen lds
s_waitcnt lgkmcnt(1)
v_mfma_f32_32x32x16_bf16 v[52:67], v[44:47], v[248:251], v[52:67]
s_waitcnt lgkmcnt(0)
v_mfma_f32_32x32x16_bf16 v[52:67], v[48:51], v[252:255], v[52:67]
v_mov_b32 v2, v76
v_mov_b32 v3, v77
v_mov_b32 v4, v78
v_mov_b32 v5, v79
s_nop 7
v_cvt_pk_bf16_f32 v52, v52, v53
v_cvt_pk_bf16_f32 v53, v54, v55
v_cvt_pk_bf16_f32 v54, v56, v57
v_cvt_pk_bf16_f32 v55, v58, v59
v_cvt_pk_bf16_f32 v56, v60, v61
v_cvt_pk_bf16_f32 v57, v62, v63
v_cvt_pk_bf16_f32 v58, v64, v65
v_cvt_pk_bf16_f32 v59, v66, v67
v_mfma_f32_32x32x16_bf16 v[84:99], v[116:119], v[52:55], 0
s_nop 0
v_mfma_f32_32x32x16_bf16 v[100:115], v[120:123], v[56:59], 0
v_lshrrev_b32 v10, 3, v0
v_and_b32 v11, 7, v0
v_bfe_u32 v12, v0, 4, 1
v_lshlrev_b32 v12, 2, v12
v_xor_b32 v11, v11, v12
v_lshlrev_b32 v11, 4, v11
v_lshl_add_u32 v10, v10, 10, v11
s_lshl_b32 s27, s26, 14
s_and_b32 s28, s25, 7
s_lshl_b32 s28, s28, 7
s_add_u32 s27, s27, s28
v_add_u32 v15, s27, v10
v_max3_f32 v10, v84, v85, v86
v_max3_f32 v11, v87, v88, v89
v_max3_f32 v10, v10, v90, v91
v_max3_f32 v11, v11, v92, v93
v_max3_f32 v10, v10, v94, v95
v_max3_f32 v11, v11, v96, v97
v_max3_f32 v10, v10, v98, v99
v_max_f32 v10, v10, v11
v_mul_f32 v10, s32, v10
v_fma_f32 v84, v84, s32, -v10
v_fma_f32 v85, v85, s32, -v10
v_fma_f32 v86, v86, s32, -v10
v_fma_f32 v87, v87, s32, -v10
v_fma_f32 v88, v88, s32, -v10
v_fma_f32 v89, v89, s32, -v10
v_fma_f32 v90, v90, s32, -v10
v_fma_f32 v91, v91, s32, -v10
v_fma_f32 v92, v92, s32, -v10
v_fma_f32 v93, v93, s32, -v10
v_fma_f32 v94, v94, s32, -v10
v_fma_f32 v95, v95, s32, -v10
v_fma_f32 v96, v96, s32, -v10
v_fma_f32 v97, v97, s32, -v10
v_fma_f32 v98, v98, s32, -v10
v_fma_f32 v99, v99, s32, -v10
v_exp_f32 v84, v84
v_exp_f32 v85, v85
v_exp_f32 v86, v86
v_exp_f32 v87, v87
v_exp_f32 v88, v88
v_exp_f32 v89, v89
v_exp_f32 v90, v90
v_exp_f32 v91, v91
v_exp_f32 v92, v92
v_exp_f32 v93, v93
v_exp_f32 v94, v94
v_exp_f32 v95, v95
v_exp_f32 v96, v96
v_exp_f32 v97, v97
v_exp_f32 v98, v98
v_exp_f32 v99, v99
v_add_f32 v10, v84, v88
v_add_f32 v11, v85, v89
v_add_f32 v12, v86, v90
v_add_f32 v13, v87, v91
v_add_f32 v10, v10, v92
v_add_f32 v11, v11, v93
v_add_f32 v12, v12, v94
v_add_f32 v13, v13, v95
v_add_f32 v10, v10, v96
v_add_f32 v11, v11, v97
v_add_f32 v12, v12, v98
v_add_f32 v13, v13, v99
v_add_f32 v10, v10, v11
v_add_f32 v12, v12, v13
v_add_f32 v10, v10, v12
v_rcp_f32 v10, v10
s_nop 0
v_mul_f32 v84, v84, v10
v_mul_f32 v85, v85, v10
v_mul_f32 v86, v86, v10
v_mul_f32 v87, v87, v10
v_mul_f32 v88, v88, v10
v_mul_f32 v89, v89, v10
v_mul_f32 v90, v90, v10
v_mul_f32 v91, v91, v10
v_mul_f32 v92, v92, v10
v_mul_f32 v93, v93, v10
v_mul_f32 v94, v94, v10
v_mul_f32 v95, v95, v10
v_mul_f32 v96, v96, v10
v_mul_f32 v97, v97, v10
v_mul_f32 v98, v98, v10
v_mul_f32 v99, v99, v10
v_cvt_pk_bf16_f32 v60, v84, v85
v_cvt_pk_bf16_f32 v61, v86, v87
v_cvt_pk_bf16_f32 v62, v88, v89
v_cvt_pk_bf16_f32 v63, v90, v91
v_cvt_pk_bf16_f32 v64, v92, v93
s_waitcnt vmcnt(4)
v_mov_b32 v18, 4
ds_write_b32 v8, v18
v_cvt_pk_bf16_f32 v65, v94, v95
v_cvt_pk_bf16_f32 v66, v96, v97
v_cvt_pk_bf16_f32 v67, v98, v99
v_mfma_f32_32x32x16_bf16 v[84:99], v[60:63], v[124:127], 0
s_nop 0
v_mfma_f32_32x32x16_bf16 v[84:99], v[64:67], v[2:5], v[84:99]
v_max3_f32 v10, v100, v101, v102
v_max3_f32 v11, v103, v104, v105
v_max3_f32 v10, v10, v106, v107
v_max3_f32 v11, v11, v108, v109
v_max3_f32 v10, v10, v110, v111
v_max3_f32 v11, v11, v112, v113
v_max3_f32 v10, v10, v114, v115
v_max_f32 v10, v10, v11
v_mul_f32 v10, s32, v10
v_fma_f32 v100, v100, s32, -v10
ds_read_b32 v19, v9 offset:0
v_fma_f32 v101, v101, s32, -v10
v_fma_f32 v102, v102, s32, -v10
v_fma_f32 v103, v103, s32, -v10
v_fma_f32 v104, v104, s32, -v10
v_fma_f32 v105, v105, s32, -v10
v_fma_f32 v106, v106, s32, -v10
v_fma_f32 v107, v107, s32, -v10
v_fma_f32 v108, v108, s32, -v10
v_fma_f32 v109, v109, s32, -v10
v_fma_f32 v110, v110, s32, -v10
v_fma_f32 v111, v111, s32, -v10
v_fma_f32 v112, v112, s32, -v10
v_fma_f32 v113, v113, s32, -v10
v_fma_f32 v114, v114, s32, -v10
v_fma_f32 v115, v115, s32, -v10
BS_9:
s_waitcnt lgkmcnt(0)
v_cmp_gt_u32 vcc, 4, v19
s_cbranch_vccz BD_10
ds_read_b32 v19, v9 offset:0
s_add_u32 s49, s49, 1
s_cmp_lt_u32 s49, 131072
s_cbranch_scc1 BS_9
BD_10:
ds_read_b64_tr_b16 v[20:21], v6 offset:32768
ds_read_b64_tr_b16 v[22:23], v6 offset:33024
ds_read_b64_tr_b16 v[24:25], v6 offset:36864
ds_read_b64_tr_b16 v[26:27], v6 offset:37120
ds_read_b64_tr_b16 v[28:29], v6 offset:40960
ds_read_b64_tr_b16 v[30:31], v6 offset:41216
ds_read_b64_tr_b16 v[32:33], v6 offset:45056
ds_read_b64_tr_b16 v[34:35], v6 offset:45312
ds_read_b64_tr_b16 v[36:37], v6 offset:33792
ds_read_b64_tr_b16 v[38:39], v6 offset:34048
ds_read_b64_tr_b16 v[40:41], v6 offset:37888
ds_read_b64_tr_b16 v[42:43], v6 offset:38144
ds_read_b64_tr_b16 v[44:45], v6 offset:41984
ds_read_b64_tr_b16 v[46:47], v6 offset:42240
ds_read_b64_tr_b16 v[48:49], v6 offset:46080
ds_read_b64_tr_b16 v[50:51], v6 offset:46336
v_exp_f32 v100, v100
v_exp_f32 v101, v101
v_exp_f32 v102, v102
v_exp_f32 v103, v103
v_exp_f32 v104, v104
v_exp_f32 v105, v105
v_exp_f32 v106, v106
v_exp_f32 v107, v107
v_exp_f32 v108, v108
v_exp_f32 v109, v109
v_exp_f32 v110, v110
v_exp_f32 v111, v111
v_exp_f32 v112, v112
v_exp_f32 v113, v113
v_exp_f32 v114, v114
v_exp_f32 v115, v115
v_add_f32 v10, v100, v104
v_add_f32 v11, v101, v105
v_add_f32 v12, v102, v106
v_add_f32 v13, v103, v107
v_add_f32 v10, v10, v108
v_add_f32 v11, v11, v109
v_add_f32 v12, v12, v110
v_add_f32 v13, v13, v111
v_add_f32 v10, v10, v112
v_add_f32 v11, v11, v113
v_add_f32 v12, v12, v114
v_add_f32 v13, v13, v115
v_add_f32 v10, v10, v11
v_add_f32 v12, v12, v13
s_waitcnt lgkmcnt(14)
v_mfma_f32_32x32x16_bf16 v[68:83], v[128:131], v[20:23], 0
ds_read_b64_tr_b16 v[20:21], v6 offset:34816
ds_read_b64_tr_b16 v[22:23], v6 offset:35072
v_add_f32 v10, v10, v12
v_rcp_f32 v10, v10
s_nop 0
v_mul_f32 v100, v100, v10
v_mul_f32 v101, v101, v10
s_waitcnt lgkmcnt(14)
v_mfma_f32_32x32x16_bf16 v[68:83], v[132:135], v[24:27], v[68:83]
ds_read_b64_tr_b16 v[24:25], v6 offset:38912
ds_read_b64_tr_b16 v[26:27], v6 offset:39168
v_mul_f32 v102, v102, v10
s_waitcnt vmcnt(0)
v_mov_b32 v18, 5
ds_write_b32 v8, v18
v_mul_f32 v103, v103, v10
v_mul_f32 v104, v104, v10
v_mul_f32 v105, v105, v10
s_waitcnt lgkmcnt(15)
v_mfma_f32_32x32x16_bf16 v[68:83], v[136:139], v[28:31], v[68:83]
ds_read_b64_tr_b16 v[28:29], v6 offset:43008
ds_read_b64_tr_b16 v[30:31], v6 offset:43264
v_mul_f32 v106, v106, v10
v_mul_f32 v107, v107, v10
v_mul_f32 v108, v108, v10
v_mul_f32 v109, v109, v10
s_waitcnt lgkmcnt(15)
v_mfma_f32_32x32x16_bf16 v[68:83], v[140:143], v[32:35], v[68:83]
ds_read_b64_tr_b16 v[32:33], v6 offset:47104
ds_read_b64_tr_b16 v[34:35], v6 offset:47360
v_mul_f32 v110, v110, v10
v_mul_f32 v111, v111, v10
v_mul_f32 v112, v112, v10
v_mul_f32 v113, v113, v10
s_waitcnt lgkmcnt(15)
v_mfma_f32_32x32x16_bf16 v[68:83], v[144:147], v[36:39], v[68:83]
ds_read_b64_tr_b16 v[36:37], v6 offset:35840
ds_read_b64_tr_b16 v[38:39], v6 offset:36096
v_mul_f32 v114, v114, v10
ds_read_b32 v19, v9 offset:0
v_mul_f32 v115, v115, v10
v_cvt_pk_bf16_f32 v52, v100, v101
v_cvt_pk_bf16_f32 v53, v102, v103
s_waitcnt lgkmcnt(15)
v_mfma_f32_32x32x16_bf16 v[68:83], v[148:151], v[40:43], v[68:83]
ds_read_b64_tr_b16 v[40:41], v6 offset:39936
ds_read_b64_tr_b16 v[42:43], v6 offset:40192
v_cvt_pk_bf16_f32 v54, v104, v105
v_cvt_pk_bf16_f32 v55, v106, v107
v_cvt_pk_bf16_f32 v56, v108, v109
v_cvt_pk_bf16_f32 v57, v110, v111
s_waitcnt lgkmcnt(15)
v_mfma_f32_32x32x16_bf16 v[68:83], v[152:155], v[44:47], v[68:83]
ds_read_b64_tr_b16 v[44:45], v6 offset:44032
ds_read_b64_tr_b16 v[46:47], v6 offset:44288
v_cvt_pk_bf16_f32 v58, v112, v113
v_cvt_pk_bf16_f32 v59, v114, v115
v_mfma_f32_32x32x16_bf16 v[100:115], v[52:55], v[124:127], 0
s_nop 0
v_mfma_f32_32x32x16_bf16 v[100:115], v[56:59], v[2:5], v[100:115]
s_waitcnt lgkmcnt(15)
v_mfma_f32_32x32x16_bf16 v[68:83], v[156:159], v[48:51], v[68:83]
ds_read_b64_tr_b16 v[48:49], v6 offset:48128
ds_read_b64_tr_b16 v[50:51], v6 offset:48384
v_add_f32 v10, v84, v88
v_add_f32 v11, v85, v89
v_add_f32 v12, v86, v90
v_add_f32 v13, v87, v91
s_waitcnt lgkmcnt(6)
v_cmp_gt_u32 vcc, 5, v19
s_cbranch_vccz BD_12
ds_read_b32 v19, v9 offset:0
BS_11:
s_waitcnt lgkmcnt(0)
v_cmp_gt_u32 vcc, 5, v19
s_cbranch_vccz BD_12
ds_read_b32 v19, v9 offset:0
s_add_u32 s49, s49, 1
s_cmp_lt_u32 s49, 131072
s_cbranch_scc1 BS_11
BD_12:
s_waitcnt lgkmcnt(9)
v_mfma_f32_32x32x16_bf16 v[68:83], v[160:163], v[20:23], v[68:83]
ds_read_b64_tr_b16 v[20:21], v7 offset:32768
ds_read_b64_tr_b16 v[22:23], v7 offset:33024
v_add_f32 v10, v10, v92
v_add_f32 v11, v11, v93
v_add_f32 v12, v12, v94
v_add_f32 v13, v13, v95
v_mfma_f32_32x32x16_bf16 v[68:83], v[164:167], v[24:27], v[68:83]
ds_read_b64_tr_b16 v[24:25], v7 offset:36864
ds_read_b64_tr_b16 v[26:27], v7 offset:37120
v_add_f32 v10, v10, v96
v_add_f32 v11, v11, v97
v_add_f32 v12, v12, v98
v_add_f32 v13, v13, v99
v_mfma_f32_32x32x16_bf16 v[68:83], v[168:171], v[28:31], v[68:83]
ds_read_b64_tr_b16 v[28:29], v7 offset:40960
ds_read_b64_tr_b16 v[30:31], v7 offset:41216
v_add_u32 v16, 0xfffff800, v16
s_add_u32 m0, s31, 49152
s_nop 0
buffer_load_dwordx4 v16, s[8:11], s16 offen lds
v_add_f32 v10, v10, v11
v_add_f32 v12, v12, v13
v_add_f32 v10, v10, v12
v_cvt_pk_bf16_f32 v84, v84, v85
v_mfma_f32_32x32x16_bf16 v[68:83], v[172:175], v[32:35], v[68:83]
ds_read_b64_tr_b16 v[32:33], v7 offset:45056
ds_read_b64_tr_b16 v[34:35], v7 offset:45312
v_cvt_pk_bf16_f32 v85, v86, v87
v_cvt_pk_bf16_f32 v86, v88, v89
v_cvt_pk_bf16_f32 v87, v90, v91
v_cvt_pk_bf16_f32 v88, v92, v93
s_waitcnt lgkmcnt(8)
v_mfma_f32_32x32x16_bf16 v[68:83], v[176:179], v[36:39], v[68:83]
ds_read_b64_tr_b16 v[36:37], v7 offset:33792
ds_read_b64_tr_b16 v[38:39], v7 offset:34048
v_cvt_pk_bf16_f32 v89, v94, v95
v_cvt_pk_bf16_f32 v90, v96, v97
v_cvt_pk_bf16_f32 v91, v98, v99
v_mov_b32 v92, v10
v_mfma_f32_32x32x16_bf16 v[68:83], v[180:183], v[40:43], v[68:83]
ds_read_b64_tr_b16 v[40:41], v7 offset:37888
ds_read_b64_tr_b16 v[42:43], v7 offset:38144
s_add_u32 m0, s31, 50176
s_nop 0
buffer_load_dwordx4 v16, s[8:11], s17 offen lds
v_add_f32 v10, v100, v104
v_add_f32 v11, v101, v105
v_add_f32 v12, v102, v106
v_add_f32 v13, v103, v107
v_mfma_f32_32x32x16_bf16 v[68:83], v[184:187], v[44:47], v[68:83]
ds_read_b64_tr_b16 v[44:45], v7 offset:41984
ds_read_b64_tr_b16 v[46:47], v7 offset:42240
v_add_f32 v10, v10, v108
v_add_f32 v11, v11, v109
v_add_f32 v12, v12, v110
v_add_f32 v13, v13, v111
v_mfma_f32_32x32x16_bf16 v[68:83], v[188:191], v[48:51], v[68:83]
ds_read_b64_tr_b16 v[48:49], v7 offset:46080
ds_read_b64_tr_b16 v[50:51], v7 offset:46336
v_add_f32 v10, v10, v112
v_add_f32 v11, v11, v113
v_add_f32 v12, v12, v114
v_add_f32 v13, v13, v115
s_waitcnt lgkmcnt(8)
v_mfma_f32_32x32x16_bf16 v[68:83], v[192:195], v[20:23], v[68:83]
ds_read_b64_tr_b16 v[20:21], v7 offset:34816
ds_read_b64_tr_b16 v[22:23], v7 offset:35072
s_add_u32 m0, s31, 51200
s_nop 0
buffer_load_dwordx4 v16, s[8:11], s18 offen lds
v_add_f32 v10, v10, v11
v_add_f32 v12, v12, v13
v_add_f32 v10, v10, v12
s_nop 1
v_permlane32_swap_b32 v92, v10
v_mfma_f32_32x32x16_bf16 v[68:83], v[196:199], v[24:27], v[68:83]
ds_read_b64_tr_b16 v[24:25], v7 offset:38912
ds_read_b64_tr_b16 v[26:27], v7 offset:39168
v_add_f32 v10, v10, v92
ds_write_b32 v14, v10
v_cvt_pk_bf16_f32 v100, v100, v101
v_cvt_pk_bf16_f32 v101, v102, v103
v_mfma_f32_32x32x16_bf16 v[68:83], v[200:203], v[28:31], v[68:83]
ds_read_b64_tr_b16 v[28:29], v7 offset:43008
ds_read_b64_tr_b16 v[30:31], v7 offset:43264
v_cvt_pk_bf16_f32 v102, v104, v105
v_cvt_pk_bf16_f32 v103, v106, v107
v_cvt_pk_bf16_f32 v104, v108, v109
v_cvt_pk_bf16_f32 v105, v110, v111
v_mfma_f32_32x32x16_bf16 v[68:83], v[204:207], v[32:35], v[68:83]
ds_read_b64_tr_b16 v[32:33], v7 offset:47104
ds_read_b64_tr_b16 v[34:35], v7 offset:47360
s_add_u32 m0, s31, 52224
s_nop 0
buffer_load_dwordx4 v16, s[8:11], s19 offen lds
v_cvt_pk_bf16_f32 v106, v112, v113
v_cvt_pk_bf16_f32 v107, v114, v115
v_mov_b32 v52, 0
v_mov_b32 v53, 0
s_waitcnt lgkmcnt(9)
v_mfma_f32_32x32x16_bf16 v[68:83], v[208:211], v[36:39], v[68:83]
ds_read_b64_tr_b16 v[36:37], v7 offset:35840
ds_read_b64_tr_b16 v[38:39], v7 offset:36096
v_mov_b32 v54, 0
v_mov_b32 v55, 0
v_mov_b32 v56, 0
v_mov_b32 v57, 0
v_mfma_f32_32x32x16_bf16 v[68:83], v[212:215], v[40:43], v[68:83]
ds_read_b64_tr_b16 v[40:41], v7 offset:39936
ds_read_b64_tr_b16 v[42:43], v7 offset:40192
v_mov_b32 v58, 0
v_mov_b32 v59, 0
v_mov_b32 v60, 0
v_mov_b32 v61, 0
v_mfma_f32_32x32x16_bf16 v[68:83], v[216:219], v[44:47], v[68:83]
ds_read_b64_tr_b16 v[44:45], v7 offset:44032
ds_read_b64_tr_b16 v[46:47], v7 offset:44288
s_add_u32 m0, s31, 65536
s_nop 0
buffer_load_dwordx4 v16, s[8:11], s20 offen lds
v_mov_b32 v62, 0
v_mov_b32 v63, 0
v_mov_b32 v64, 0
v_mov_b32 v65, 0
v_mfma_f32_32x32x16_bf16 v[68:83], v[220:223], v[48:51], v[68:83]
ds_read_b64_tr_b16 v[48:49], v7 offset:48128
ds_read_b64_tr_b16 v[50:51], v7 offset:48384
v_mov_b32 v66, 0
v_mov_b32 v67, 0
v_bfe_u32 v10, v0, 1, 3
v_lshrrev_b32 v11, 5, v0
s_waitcnt lgkmcnt(8)
v_mfma_f32_32x32x16_bf16 v[68:83], v[224:227], v[20:23], v[68:83]
v_lshlrev_b32 v11, 2, v11
v_xor_b32 v10, v10, v11
v_lshlrev_b32 v10, 4, v10
v_and_b32 v11, 31, v0
v_mfma_f32_32x32x16_bf16 v[68:83], v[228:231], v[24:27], v[68:83]
s_add_u32 m0, s31, 66560
s_nop 0
buffer_load_dwordx4 v16, s[8:11], s21 offen lds
v_lshl_add_u32 v10, v11, 7, v10
s_add_u32 s27, s31, 0
v_add_u32 v2, s27, v10
v_xor_b32 v3, 16, v2
v_mfma_f32_32x32x16_bf16 v[68:83], v[232:235], v[28:31], v[68:83]
v_xor_b32 v4, 32, v2
v_xor_b32 v5, 48, v2
v_and_b32 v10, 3, v0
v_lshlrev_b32 v11, 1, v10
v_mfma_f32_32x32x16_bf16 v[68:83], v[236:239], v[32:35], v[68:83]
v_bfe_u32 v12, v0, 3, 2
s_and_b32 s27, s26, 1
s_lshl_b32 s27, s27, 2
v_add_u32 v12, s27, v12
s_waitcnt lgkmcnt(0)
v_mfma_f32_32x32x16_bf16 v[68:83], v[240:243], v[36:39], v[68:83]
s_add_u32 m0, s31, 67584
s_nop 0
buffer_load_dwordx4 v16, s[8:11], s22 offen lds
v_xor_b32 v11, v11, v12
v_lshlrev_b32 v11, 4, v11
v_lshrrev_b32 v12, 2, v0
v_lshl_add_u32 v11, v12, 7, v11
v_mfma_f32_32x32x16_bf16 v[68:83], v[244:247], v[40:43], v[68:83]
s_lshl_b32 s27, s26, 10
s_add_u32 s27, s27, 0
v_add_u32 v11, s27, v11
v_and_b32 v12, 1, v12
v_mfma_f32_32x32x16_bf16 v[68:83], v[248:251], v[44:47], v[68:83]
v_lshlrev_b32 v12, 7, v12
v_lshl_add_u32 v12, v10, 5, v12
v_add_u32 v12, 16384, v12
s_mov_b32 vcc_lo, 0
s_mov_b32 vcc_hi, -1
v_cndmask_b32 v124, v11, v12, vcc
v_mfma_f32_32x32x16_bf16 v[68:83], v[252:255], v[48:51], v[68:83]
s_add_u32 m0, s31, 68608
s_nop 0
buffer_load_dwordx4 v16, s[8:11], s23 offen lds
v_xor_b32 v125, 16, v124
s_lshl_b32 s27, s25, 15
s_lshl_b32 s28, s26, 13
s_add_u32 s27, s27, s28
s_lshl_b32 s28, s24, 9
s_add_u32 s27, s27, s28
s_add_u32 s27, s27, 6291456
v_lshlrev_b32 v10, 4, v0
v_add_u32 v126, s27, v10
s_lshl_b32 s27, s25, 13
s_lshl_b32 s28, s24, 9
s_add_u32 s27, s27, s28
s_add_u32 s27, s27, 6815744
v_and_b32 v10, 0x70, v10
v_add_u32 v10, s27, v10
s_mov_b32 vcc_lo, 0
s_mov_b32 vcc_hi, -1
v_cndmask_b32 v126, v126, v10, vcc
s_mov_b32 exec_lo, 0x0000ffff
s_mov_b32 exec_hi, 0x0000ffff
v_cvt_pk_bf16_f32 v52, v68, v69
v_cvt_pk_bf16_f32 v53, v70, v71
v_cvt_pk_bf16_f32 v54, v72, v73
v_cvt_pk_bf16_f32 v55, v74, v75
v_cvt_pk_bf16_f32 v56, v76, v77
v_cvt_pk_bf16_f32 v57, v78, v79
v_cvt_pk_bf16_f32 v58, v80, v81
v_cvt_pk_bf16_f32 v59, v82, v83
s_mov_b64 exec, -1
v_mfma_f32_32x32x16_bf16 v[20:35], v[84:87], v[52:55], 0
v_mfma_f32_32x32x16_bf16 v[20:35], v[88:91], v[56:59], v[20:35]
s_mov_b32 exec_lo, 0xffff0000
s_mov_b32 exec_hi, 0xffff0000
v_cvt_pk_bf16_f32 v60, v68, v69
v_cvt_pk_bf16_f32 v61, v70, v71
v_cvt_pk_bf16_f32 v62, v72, v73
v_cvt_pk_bf16_f32 v63, v74, v75
v_cvt_pk_bf16_f32 v64, v76, v77
v_cvt_pk_bf16_f32 v65, v78, v79
v_cvt_pk_bf16_f32 v66, v80, v81
v_cvt_pk_bf16_f32 v67, v82, v83
s_mov_b64 exec, -1
v_mfma_f32_32x32x16_bf16 v[20:35], v[100:103], v[60:63], v[20:35]
v_mfma_f32_32x32x16_bf16 v[20:35], v[104:107], v[64:67], v[20:35]
v_lshrrev_b32 v127, 2, v126
s_nop 10
ds_write_b128 v2, v[20:23]
ds_write_b128 v3, v[24:27]
ds_write_b128 v4, v[28:31]
ds_write_b128 v5, v[32:35]
s_waitcnt vmcnt(4)
v_mov_b32 v18, 6
ds_write_b32 v8, v18
ds_read_b32 v19, v9 offset:0
BS_13:
s_waitcnt lgkmcnt(0)
v_cmp_gt_u32 vcc, 6, v19
s_cbranch_vccz BD_14
ds_read_b32 v19, v9 offset:0
s_add_u32 s49, s49, 1
s_cmp_lt_u32 s49, 131072
s_cbranch_scc1 BS_13
BD_14:
s_mov_b32 exec_hi, s35
ds_read_b128 v[52:55], v124 offset:0
ds_read_b128 v[56:59], v125 offset:0
ds_read_b128 v[60:63], v124 offset:4096
ds_read_b128 v[64:67], v125 offset:4096
ds_read_b128 v[68:71], v124 offset:8192
ds_read_b128 v[72:75], v125 offset:8192
ds_read_b128 v[76:79], v124 offset:12288
ds_read_b128 v[80:83], v125 offset:12288
s_waitcnt lgkmcnt(4)
v_pk_add_f32 v[52:53], v[52:53], v[60:61]
v_pk_add_f32 v[54:55], v[54:55], v[62:63]
v_pk_add_f32 v[56:57], v[56:57], v[64:65]
v_pk_add_f32 v[58:59], v[58:59], v[66:67]
s_waitcnt lgkmcnt(0)
v_pk_add_f32 v[68:69], v[68:69], v[76:77]
v_pk_add_f32 v[70:71], v[70:71], v[78:79]
v_pk_add_f32 v[72:73], v[72:73], v[80:81]
v_pk_add_f32 v[74:75], v[74:75], v[82:83]
v_pk_add_f32 v[52:53], v[52:53], v[68:69]
v_pk_add_f32 v[54:55], v[54:55], v[70:71]
v_pk_add_f32 v[56:57], v[56:57], v[72:73]
v_pk_add_f32 v[58:59], v[58:59], v[74:75]
v_cvt_pk_bf16_f32 v60, v52, v53
v_cvt_pk_bf16_f32 v61, v54, v55
v_cvt_pk_bf16_f32 v62, v56, v57
v_cvt_pk_bf16_f32 v63, v58, v59
v_add3_u32 v52, v60, v61, v62
v_add3_u32 v52, v52, v63, s48
buffer_store_dwordx4 v[60:63], v126, s[12:15], 0 offen sc1
buffer_store_dword v52, v127, s[12:15], s62 offen sc1
s_mov_b32 exec_hi, -1
v_mov_b32 v18, 7
ds_write_b32 v8, v18
ds_read_b64_tr_b16 v[20:21], v6 offset:49152
ds_read_b64_tr_b16 v[22:23], v6 offset:49408
ds_read_b64_tr_b16 v[24:25], v6 offset:53248
ds_read_b64_tr_b16 v[26:27], v6 offset:53504
ds_read_b64_tr_b16 v[28:29], v6 offset:57344
ds_read_b64_tr_b16 v[30:31], v6 offset:57600
ds_read_b64_tr_b16 v[32:33], v6 offset:61440
ds_read_b64_tr_b16 v[34:35], v6 offset:61696
ds_read_b64_tr_b16 v[36:37], v6 offset:50176
ds_read_b64_tr_b16 v[38:39], v6 offset:50432
ds_read_b64_tr_b16 v[40:41], v6 offset:54272
ds_read_b64_tr_b16 v[42:43], v6 offset:54528
ds_read_b64_tr_b16 v[44:45], v6 offset:58368
ds_read_b64_tr_b16 v[46:47], v6 offset:58624
ds_read_b64_tr_b16 v[48:49], v6 offset:62464
ds_read_b64_tr_b16 v[50:51], v6 offset:62720
v_bfe_u32 v10, v0, 3, 1
v_bfe_u32 v11, v0, 4, 1
v_cmp_eq_u32 vcc, v10, v11
v_and_b32 v10, 1, v0
v_lshlrev_b32 v10, 4, v10
v_mov_b32 v12, 0x3f80
v_lshlrev_b32 v12, v10, v12
v_cndmask_b32 v12, 0, v12, vcc
v_bfe_u32 v10, v0, 1, 2
v_cmp_eq_u32 vcc, 0, v10
s_nop 1
v_cndmask_b32 v2, 0, v12, vcc
v_cmp_eq_u32 vcc, 1, v10
s_nop 1
v_cndmask_b32 v3, 0, v12, vcc
v_cmp_eq_u32 vcc, 2, v10
s_nop 1
v_cndmask_b32 v4, 0, v12, vcc
v_cmp_eq_u32 vcc, 3, v10
s_nop 1
v_cndmask_b32 v5, 0, v12, vcc
v_lshlrev_b32 v79, 5, v0
s_lshl_b32 s1, s48, 3
buffer_load_dwordx4 v[68:71], v79, s[12:15], s3 offen offset:0 sc1
buffer_load_dwordx4 v[72:75], v79, s[12:15], s3 offen offset:16 sc1
s_waitcnt lgkmcnt(8)
v_mfma_f32_32x32x16_bf16 v[52:67], v[20:23], v[128:131], 0
ds_read_b64_tr_b16 v[20:21], v6 offset:51200
ds_read_b64_tr_b16 v[22:23], v6 offset:51456
v_lshrrev_b32 v10, 5, v0
s_and_b32 s27, s26, 1
v_mfma_f32_32x32x16_bf16 v[52:67], v[24:27], v[132:135], v[52:67]
s_waitcnt vmcnt(4)
v_mov_b32 v18, 8
ds_write_b32 v8, v18
ds_read_b64_tr_b16 v[24:25], v6 offset:55296
ds_read_b64_tr_b16 v[26:27], v6 offset:55552
s_lshl_b32 s27, s27, 1
v_add_u32 v10, s27, v10
s_add_u32 m0, s31, 81920
s_mov_b32 s37, 0
buffer_load_dwordx4 v15, s[40:43], s37 offen offset:0 lds
v_mfma_f32_32x32x16_bf16 v[52:67], v[28:31], v[136:139], v[52:67]
ds_read_b64_tr_b16 v[28:29], v6 offset:59392
ds_read_b64_tr_b16 v[30:31], v6 offset:59648
v_and_b32 v11, 3, v0
v_xor_b32 v12, v11, v10
v_mfma_f32_32x32x16_bf16 v[52:67], v[32:35], v[140:143], v[52:67]
ds_read_b64_tr_b16 v[32:33], v6 offset:63488
ds_read_b64_tr_b16 v[34:35], v6 offset:63744
v_lshlrev_b32 v12, 4, v12
v_lshl_add_u32 v12, v10, 8, v12
s_add_u32 m0, s31, 81920
s_mov_b32 s37, 7168
buffer_load_dwordx4 v15, s[40:43], s37 offen offset:1024 lds
s_waitcnt lgkmcnt(9)
v_mfma_f32_32x32x16_bf16 v[52:67], v[36:39], v[144:147], v[52:67]
ds_read_b64_tr_b16 v[36:37], v6 offset:52224
ds_read_b64_tr_b16 v[38:39], v6 offset:52480
v_bfe_u32 v13, v0, 2, 2
v_lshl_add_u32 v12, v13, 6, v12
v_mfma_f32_32x32x16_bf16 v[52:67], v[40:43], v[148:151], v[52:67]
ds_read_b32 v19, v9 offset:0
ds_read_b64_tr_b16 v[40:41], v6 offset:56320
ds_read_b64_tr_b16 v[42:43], v6 offset:56576
v_bfe_u32 v13, v0, 4, 1
v_lshl_add_u32 v12, v13, 3, v12
s_add_u32 m0, s31, 83968
s_mov_b32 s37, 65536
buffer_load_dwordx4 v15, s[40:43], s37 offen offset:0 lds
v_mfma_f32_32x32x16_bf16 v[52:67], v[44:47], v[152:155], v[52:67]
ds_read_b64_tr_b16 v[44:45], v6 offset:60416
ds_read_b64_tr_b16 v[46:47], v6 offset:60672
s_lshr_b32 s27, s26, 1
s_lshl_b32 s27, s27, 11
v_mfma_f32_32x32x16_bf16 v[52:67], v[48:51], v[156:159], v[52:67]
ds_read_b64_tr_b16 v[48:49], v6 offset:64512
ds_read_b64_tr_b16 v[50:51], v6 offset:64768
s_add_u32 s27, s27, 0
v_add_u32 v124, s27, v12
s_add_u32 m0, s31, 83968
s_mov_b32 s37, 72704
buffer_load_dwordx4 v15, s[40:43], s37 offen offset:1024 lds
s_waitcnt lgkmcnt(9)
v_mfma_f32_32x32x16_bf16 v[52:67], v[20:23], v[160:163], v[52:67]
s_waitcnt lgkmcnt(6)
v_cmp_gt_u32 vcc, 8, v19
s_cbranch_vccz BD_16
ds_read_b32 v19, v9 offset:0
BS_15:
s_waitcnt lgkmcnt(0)
v_cmp_gt_u32 vcc, 8, v19
s_cbranch_vccz BD_16
ds_read_b32 v19, v9 offset:0
s_add_u32 s49, s49, 1
s_cmp_lt_u32 s49, 131072
s_cbranch_scc1 BS_15
BD_16:
ds_read_b64_tr_b16 v[20:21], v7 offset:0
ds_read_b64_tr_b16 v[22:23], v7 offset:256
v_xor_b32 v11, s26, v11
v_lshlrev_b32 v11, 4, v11
v_mfma_f32_32x32x16_bf16 v[52:67], v[24:27], v[164:167], v[52:67]
ds_read_b64_tr_b16 v[24:25], v7 offset:4096
ds_read_b64_tr_b16 v[26:27], v7 offset:4352
v_bfe_u32 v12, v0, 3, 2
v_lshl_add_u32 v11, v12, 6, v11
s_add_u32 m0, s31, 32768
s_mov_b32 s37, 131072
buffer_load_dwordx4 v15, s[40:43], s37 offen offset:0 lds
v_mfma_f32_32x32x16_bf16 v[52:67], v[28:31], v[168:171], v[52:67]
ds_read_b64_tr_b16 v[28:29], v7 offset:8192
ds_read_b64_tr_b16 v[30:31], v7 offset:8448
v_bfe_u32 v12, v0, 2, 1
v_lshl_add_u32 v11, v12, 11, v11
v_mfma_f32_32x32x16_bf16 v[52:67], v[32:35], v[172:175], v[52:67]
ds_read_b64_tr_b16 v[32:33], v7 offset:12288
ds_read_b64_tr_b16 v[34:35], v7 offset:12544
s_lshl_b32 s27, s26, 8
s_add_u32 s27, s27, 1024
s_add_u32 m0, s31, 32768
s_mov_b32 s37, 138240
buffer_load_dwordx4 v15, s[40:43], s37 offen offset:1024 lds
s_waitcnt lgkmcnt(8)
v_mfma_f32_32x32x16_bf16 v[52:67], v[36:39], v[176:179], v[52:67]
ds_read_b64_tr_b16 v[36:37], v7 offset:1024
ds_read_b64_tr_b16 v[38:39], v7 offset:1280
v_add_u32 v125, s27, v11
v_lshrrev_b32 v10, 5, v0
v_mfma_f32_32x32x16_bf16 v[52:67], v[40:43], v[180:183], v[52:67]
ds_read_b64_tr_b16 v[40:41], v7 offset:5120
ds_read_b64_tr_b16 v[42:43], v7 offset:5376
v_lshlrev_b32 v10, 1, v10
v_bfe_u32 v11, v0, 2, 2
s_add_u32 m0, s31, 34816
s_mov_b32 s37, 196608
buffer_load_dwordx4 v15, s[40:43], s37 offen offset:0 lds
v_mfma_f32_32x32x16_bf16 v[52:67], v[44:47], v[184:187], v[52:67]
ds_read_b64_tr_b16 v[44:45], v7 offset:9216
ds_read_b64_tr_b16 v[46:47], v7 offset:9472
v_xor_b32 v10, v10, v11
v_lshlrev_b32 v10, 4, v10
v_mfma_f32_32x32x16_bf16 v[52:67], v[48:51], v[188:191], v[52:67]
ds_read_b64_tr_b16 v[48:49], v7 offset:13312
ds_read_b64_tr_b16 v[50:51], v7 offset:13568
v_and_b32 v11, 31, v0
v_lshl_add_u32 v10, v11, 6, v10
s_add_u32 m0, s31, 34816
s_mov_b32 s37, 203776
buffer_load_dwordx4 v15, s[40:43], s37 offen offset:1024 lds
s_waitcnt lgkmcnt(8)
v_mfma_f32_32x32x16_bf16 v[52:67], v[20:23], v[192:195], v[52:67]
ds_read_b64_tr_b16 v[20:21], v7 offset:2048
ds_read_b64_tr_b16 v[22:23], v7 offset:2304
v_add_u32 v126, 0, v10
v_xor_b32 v127, 16, v126
v_mfma_f32_32x32x16_bf16 v[52:67], v[24:27], v[196:199], v[52:67]
ds_read_b64_tr_b16 v[24:25], v7 offset:6144
ds_read_b64_tr_b16 v[26:27], v7 offset:6400
v_bfe_u32 v10, v0, 3, 2
v_and_b32 v14, 0x70, v17
s_add_u32 m0, s31, 98304
s_mov_b32 s37, 262144
buffer_load_dwordx4 v15, s[40:43], s37 offen offset:0 lds
v_mfma_f32_32x32x16_bf16 v[52:67], v[28:31], v[200:203], v[52:67]
ds_read_b64_tr_b16 v[28:29], v7 offset:10240
ds_read_b64_tr_b16 v[30:31], v7 offset:10496
v_lshl_add_u32 v14, v10, 9, v14
v_mfma_f32_32x32x16_bf16 v[52:67], v[32:35], v[204:207], v[52:67]
ds_read_b64_tr_b16 v[32:33], v7 offset:14336
ds_read_b64_tr_b16 v[34:35], v7 offset:14592
s_add_u32 m0, s31, 98304
s_mov_b32 s37, 269312
buffer_load_dwordx4 v15, s[40:43], s37 offen offset:1024 lds
s_waitcnt lgkmcnt(8)
v_mfma_f32_32x32x16_bf16 v[52:67], v[36:39], v[208:211], v[52:67]
ds_read_b64_tr_b16 v[36:37], v7 offset:3072
ds_read_b64_tr_b16 v[38:39], v7 offset:3328
s_mov_b32 s51, 0
BTC_17:
s_waitcnt vmcnt(10)
v_add3_u32 v76, v68, v69, v70
v_add3_u32 v77, v71, v72, v73
v_add3_u32 v76, v76, v74, v75
v_add_u32 v76, v76, v77
v_mov_b32 v77, v76
s_nop 1
v_permlane32_swap_b32 v76, v77
v_add_u32 v76, s1, v76
v_cmp_ne_u32 vcc, v76, v77
s_cbranch_vccnz BTR_18
BTK_19:
v_add_f32 v68, v68, v69
v_add_f32 v70, v70, v71
v_mfma_f32_32x32x16_bf16 v[52:67], v[40:43], v[212:215], v[52:67]
ds_read_b64_tr_b16 v[40:41], v7 offset:7168
ds_read_b64_tr_b16 v[42:43], v7 offset:7424
v_add_f32 v72, v72, v73
v_add_f32 v74, v74, v75
s_add_u32 m0, s31, 100352
s_mov_b32 s37, 327680
buffer_load_dwordx4 v15, s[40:43], s37 offen offset:0 lds
v_mfma_f32_32x32x16_bf16 v[52:67], v[44:47], v[216:219], v[52:67]
ds_read_b64_tr_b16 v[44:45], v7 offset:11264
ds_read_b64_tr_b16 v[46:47], v7 offset:11520
v_add_f32 v68, v68, v70
v_add_f32 v72, v72, v74
v_mfma_f32_32x32x16_bf16 v[52:67], v[48:51], v[220:223], v[52:67]
ds_read_b64_tr_b16 v[48:49], v7 offset:15360
ds_read_b64_tr_b16 v[50:51], v7 offset:15616
s_lshl_b32 s27, s26, 7
v_add_f32 v68, v68, v72
s_add_u32 m0, s31, 100352
s_mov_b32 s37, 334848
buffer_load_dwordx4 v15, s[40:43], s37 offen offset:1024 lds
s_waitcnt lgkmcnt(8)
v_mfma_f32_32x32x16_bf16 v[52:67], v[20:23], v[224:227], v[52:67]
s_add_u32 s27, s27, 118272
v_mul_f32 v1, s32, v68
v_mfma_f32_32x32x16_bf16 v[52:67], v[24:27], v[228:231], v[52:67]
v_and_b32 v76, 31, v0
v_mov_b32 v68, v1
s_add_u32 m0, s31, 16384
s_mov_b32 s37, 393216
buffer_load_dwordx4 v15, s[40:43], s37 offen offset:0 lds
v_mfma_f32_32x32x16_bf16 v[52:67], v[28:31], v[232:235], v[52:67]
v_lshlrev_b32 v76, 2, v76
v_add_u32 v76, s27, v76
v_mfma_f32_32x32x16_bf16 v[52:67], v[32:35], v[236:239], v[52:67]
v_permlane32_swap_b32 v1, v68
v_exp_f32 v1, v1
s_add_u32 m0, s31, 16384
s_mov_b32 s37, 400384
buffer_load_dwordx4 v15, s[40:43], s37 offen offset:1024 lds
s_waitcnt lgkmcnt(0)
v_mfma_f32_32x32x16_bf16 v[52:67], v[36:39], v[240:243], v[52:67]
v_add_f32 v1, 1.0, v1
v_rcp_f32 v1, v1
v_mfma_f32_32x32x16_bf16 v[52:67], v[40:43], v[244:247], v[52:67]
ds_write_b32 v76, v1
s_add_u32 m0, s31, 18432
s_mov_b32 s37, 458752
buffer_load_dwordx4 v15, s[40:43], s37 offen offset:0 lds
v_mfma_f32_32x32x16_bf16 v[52:67], v[44:47], v[248:251], v[52:67]
v_mfma_f32_32x32x16_bf16 v[52:67], v[48:51], v[252:255], v[52:67]
s_add_u32 m0, s31, 18432
s_mov_b32 s37, 465920
buffer_load_dwordx4 v15, s[40:43], s37 offen offset:1024 lds
s_nop 8
v_cvt_pk_bf16_f32 v20, v52, v53
v_cvt_pk_bf16_f32 v21, v54, v55
v_cvt_pk_bf16_f32 v22, v56, v57
v_cvt_pk_bf16_f32 v23, v58, v59
v_cvt_pk_bf16_f32 v24, v60, v61
v_cvt_pk_bf16_f32 v25, v62, v63
v_cvt_pk_bf16_f32 v26, v64, v65
v_cvt_pk_bf16_f32 v27, v66, v67
v_mfma_f32_32x32x16_bf16 v[84:99], v[116:119], v[20:23], 0
s_nop 0
v_mfma_f32_32x32x16_bf16 v[100:115], v[120:123], v[24:27], 0
v_lshlrev_b32 v15, 2, v0
v_lshrrev_b32 v16, 2, v14
v_lshrrev_b32 v10, 5, v0
v_bfe_u32 v11, v0, 2, 2
v_lshl_add_u32 v10, v10, 2, v11
v_lshlrev_b32 v10, 7, v10
v_bfe_u32 v12, v0, 1, 1
v_lshl_add_u32 v10, v12, 3, v10
v_and_b32 v12, 1, v0
v_bfe_u32 v13, v0, 4, 1
v_lshl_add_u32 v12, v12, 1, v13
s_and_b32 s27, s26, 1
s_lshl_b32 s28, s27, 2
v_add_u32 v12, s28, v12
v_bfe_u32 v13, v0, 3, 1
v_lshlrev_b32 v13, 2, v13
v_xor_b32 v12, v12, v13
v_lshl_add_u32 v10, v12, 4, v10
s_mul_i32 s28, s27, 0xffffc000
s_mul_i32 s27, s27, 0x4000
s_add_u32 s27, s27, 81920
s_add_u32 s28, s28, 32768
v_add_u32 v6, s27, v10
v_add_u32 v7, s28, v10
v_max3_f32 v10, v84, v85, v86
v_max3_f32 v11, v87, v88, v89
v_max3_f32 v10, v10, v90, v91
v_max3_f32 v11, v11, v92, v93
v_max3_f32 v10, v10, v94, v95
v_max3_f32 v11, v11, v96, v97
v_max3_f32 v10, v10, v98, v99
v_max_f32 v10, v10, v11
v_mul_f32 v10, s32, v10
v_fma_f32 v84, v84, s32, -v10
v_fma_f32 v85, v85, s32, -v10
v_fma_f32 v86, v86, s32, -v10
v_fma_f32 v87, v87, s32, -v10
v_fma_f32 v88, v88, s32, -v10
v_fma_f32 v89, v89, s32, -v10
v_fma_f32 v90, v90, s32, -v10
v_fma_f32 v91, v91, s32, -v10
v_fma_f32 v92, v92, s32, -v10
v_fma_f32 v93, v93, s32, -v10
v_fma_f32 v94, v94, s32, -v10
v_fma_f32 v95, v95, s32, -v10
v_fma_f32 v96, v96, s32, -v10
v_fma_f32 v97, v97, s32, -v10
v_fma_f32 v98, v98, s32, -v10
v_fma_f32 v99, v99, s32, -v10
v_exp_f32 v84, v84
v_exp_f32 v85, v85
v_exp_f32 v86, v86
buffer_load_dword v128, v15, s[12:15], s55 offen offset:0 sc1
v_exp_f32 v87, v87
v_exp_f32 v88, v88
v_exp_f32 v89, v89
v_exp_f32 v90, v90
v_exp_f32 v91, v91
buffer_load_dwordx4 v[28:31], v17, s[12:15], s52 offen offset:0 sc1
v_exp_f32 v92, v92
v_exp_f32 v93, v93
v_exp_f32 v94, v94
v_exp_f32 v95, v95
v_exp_f32 v96, v96
buffer_load_dword v129, v15, s[12:15], s55 offen offset:256 sc1
v_exp_f32 v97, v97
v_exp_f32 v98, v98
v_exp_f32 v99, v99
v_add_f32 v10, v84, v88
v_add_f32 v11, v85, v89
buffer_load_dwordx4 v[32:35], v17, s[12:15], s52 offen offset:1024 sc1
v_add_f32 v12, v86, v90
v_add_f32 v13, v87, v91
v_add_f32 v10, v10, v92
v_add_f32 v11, v11, v93
v_add_f32 v12, v12, v94
buffer_load_dword v130, v15, s[12:15], s55 offen offset:512 sc1
v_add_f32 v13, v13, v95
v_add_f32 v10, v10, v96
v_add_f32 v11, v11, v97
v_add_f32 v12, v12, v98
v_add_f32 v13, v13, v99
buffer_load_dwordx4 v[36:39], v17, s[12:15], s52 offen offset:2048 sc1
v_add_f32 v10, v10, v11
v_add_f32 v12, v12, v13
v_add_f32 v10, v10, v12
v_rcp_f32 v10, v10
s_nop 0
v_mul_f32 v84, v84, v10
buffer_load_dword v131, v15, s[12:15], s55 offen offset:768 sc1
v_mul_f32 v85, v85, v10
v_mul_f32 v86, v86, v10
v_mul_f32 v87, v87, v10
v_mul_f32 v88, v88, v10
v_mul_f32 v89, v89, v10
buffer_load_dwordx4 v[40:43], v17, s[12:15], s52 offen offset:3072 sc1
v_mul_f32 v90, v90, v10
v_mul_f32 v91, v91, v10
v_mul_f32 v92, v92, v10
v_mul_f32 v93, v93, v10
v_mul_f32 v94, v94, v10
buffer_load_dword v132, v15, s[12:15], s55 offen offset:1024 sc1
v_mul_f32 v95, v95, v10
v_mul_f32 v96, v96, v10
v_mul_f32 v97, v97, v10
v_mul_f32 v98, v98, v10
v_mul_f32 v99, v99, v10
buffer_load_dwordx4 v[44:47], v17, s[12:15], s53 offen offset:0 sc1
v_cvt_pk_bf16_f32 v68, v84, v85
v_cvt_pk_bf16_f32 v69, v86, v87
v_cvt_pk_bf16_f32 v70, v88, v89
v_cvt_pk_bf16_f32 v71, v90, v91
v_cvt_pk_bf16_f32 v72, v92, v93
buffer_load_dword v133, v15, s[12:15], s55 offen offset:1280 sc1
v_cvt_pk_bf16_f32 v73, v94, v95
v_cvt_pk_bf16_f32 v74, v96, v97
v_cvt_pk_bf16_f32 v75, v98, v99
v_max3_f32 v10, v100, v101, v102
v_max3_f32 v11, v103, v104, v105
buffer_load_dwordx4 v[48:51], v17, s[12:15], s53 offen offset:1024 sc1
v_max3_f32 v10, v10, v106, v107
v_max3_f32 v11, v11, v108, v109
v_max3_f32 v10, v10, v110, v111
v_max3_f32 v11, v11, v112, v113
v_max3_f32 v10, v10, v114, v115
buffer_load_dword v134, v15, s[12:15], s55 offen offset:1536 sc1
v_max_f32 v10, v10, v11
v_mul_f32 v10, s32, v10
v_fma_f32 v100, v100, s32, -v10
v_fma_f32 v101, v101, s32, -v10
v_fma_f32 v102, v102, s32, -v10
buffer_load_dwordx4 v[52:55], v17, s[12:15], s53 offen offset:2048 sc1
v_fma_f32 v103, v103, s32, -v10
v_fma_f32 v104, v104, s32, -v10
v_fma_f32 v105, v105, s32, -v10
v_fma_f32 v106, v106, s32, -v10
v_fma_f32 v107, v107, s32, -v10
buffer_load_dword v135, v15, s[12:15], s55 offen offset:1792 sc1
v_fma_f32 v108, v108, s32, -v10
v_fma_f32 v109, v109, s32, -v10
v_fma_f32 v110, v110, s32, -v10
v_fma_f32 v111, v111, s32, -v10
v_fma_f32 v112, v112, s32, -v10
buffer_load_dwordx4 v[56:59], v17, s[12:15], s53 offen offset:3072 sc1
v_fma_f32 v113, v113, s32, -v10
v_fma_f32 v114, v114, s32, -v10
v_fma_f32 v115, v115, s32, -v10
v_exp_f32 v100, v100
v_exp_f32 v101, v101
buffer_load_dword v136, v16, s[12:15], s38 offen sc1
v_exp_f32 v102, v102
v_exp_f32 v103, v103
v_exp_f32 v104, v104
v_exp_f32 v105, v105
v_exp_f32 v106, v106
buffer_load_dwordx4 v[60:63], v14, s[12:15], s54 offen sc1
v_exp_f32 v107, v107
v_exp_f32 v108, v108
v_exp_f32 v109, v109
v_exp_f32 v110, v110
v_exp_f32 v111, v111
v_exp_f32 v112, v112
v_exp_f32 v113, v113
v_exp_f32 v114, v114
v_exp_f32 v115, v115
v_add_f32 v10, v100, v104
v_add_f32 v11, v101, v105
v_add_f32 v12, v102, v106
v_add_f32 v13, v103, v107
v_add_f32 v10, v10, v108
v_add_f32 v11, v11, v109
v_add_f32 v12, v12, v110
v_add_f32 v13, v13, v111
v_add_f32 v10, v10, v112
v_add_f32 v11, v11, v113
v_add_f32 v12, v12, v114
v_add_f32 v13, v13, v115
v_add_f32 v10, v10, v11
v_add_f32 v12, v12, v13
v_add_f32 v10, v10, v12
v_rcp_f32 v10, v10
s_nop 0
v_mul_f32 v100, v100, v10
v_mul_f32 v101, v101, v10
v_mul_f32 v102, v102, v10
v_mul_f32 v103, v103, v10
v_mul_f32 v104, v104, v10
v_mul_f32 v105, v105, v10
v_mul_f32 v106, v106, v10
v_mul_f32 v107, v107, v10
v_mul_f32 v108, v108, v10
v_mul_f32 v109, v109, v10
v_mul_f32 v110, v110, v10
v_mul_f32 v111, v111, v10
v_mul_f32 v112, v112, v10
v_mul_f32 v113, v113, v10
v_mul_f32 v114, v114, v10
v_mul_f32 v115, v115, v10
v_cvt_pk_bf16_f32 v76, v100, v101
v_cvt_pk_bf16_f32 v77, v102, v103
v_cvt_pk_bf16_f32 v78, v104, v105
v_cvt_pk_bf16_f32 v79, v106, v107
v_cvt_pk_bf16_f32 v80, v108, v109
v_cvt_pk_bf16_f32 v81, v110, v111
v_cvt_pk_bf16_f32 v82, v112, v113
v_cvt_pk_bf16_f32 v83, v114, v115
v_xor_b32 v116, 64, v6
v_xor_b32 v117, 64, v7
s_mov_b32 s51, 0
BGC_20:
s_waitcnt vmcnt(16)
v_mfma_f32_16x16x32_bf16 v[64:67], v[2:5], v[28:31], 0
v_add3_u32 v10, v28, v29, v30
v_add3_u32 v10, v10, v31, s48
v_xor_b32 v11, v10, v128
s_waitcnt vmcnt(14)
v_mfma_f32_16x16x32_bf16 v[64:67], v[2:5], v[32:35], v[64:67]
v_add3_u32 v10, v32, v33, v34
v_add3_u32 v10, v10, v35, s48
v_xad_u32 v11, v10, v129, v11
s_waitcnt vmcnt(12)
v_mfma_f32_16x16x32_bf16 v[64:67], v[2:5], v[36:39], v[64:67]
v_add3_u32 v10, v36, v37, v38
v_add3_u32 v10, v10, v39, s48
v_xad_u32 v11, v10, v130, v11
s_waitcnt vmcnt(10)
v_mfma_f32_16x16x32_bf16 v[64:67], v[2:5], v[40:43], v[64:67]
v_add3_u32 v10, v40, v41, v42
v_add3_u32 v10, v10, v43, s48
v_xad_u32 v11, v10, v131, v11
s_waitcnt vmcnt(8)
v_mfma_f32_16x16x32_bf16 v[64:67], v[2:5], v[44:47], v[64:67]
v_add3_u32 v10, v44, v45, v46
v_add3_u32 v10, v10, v47, s48
v_xad_u32 v11, v10, v132, v11
s_waitcnt vmcnt(6)
v_mfma_f32_16x16x32_bf16 v[64:67], v[2:5], v[48:51], v[64:67]
v_add3_u32 v10, v48, v49, v50
v_add3_u32 v10, v10, v51, s48
v_xad_u32 v11, v10, v133, v11
s_waitcnt vmcnt(4)
v_mfma_f32_16x16x32_bf16 v[64:67], v[2:5], v[52:55], v[64:67]
v_add3_u32 v10, v52, v53, v54
v_add3_u32 v10, v10, v55, s48
v_xad_u32 v11, v10, v134, v11
s_waitcnt vmcnt(2)
v_mfma_f32_16x16x32_bf16 v[64:67], v[2:5], v[56:59], v[64:67]
v_add3_u32 v10, v56, v57, v58
v_add3_u32 v10, v10, v59, s48
v_xad_u32 v11, v10, v135, v11
s_waitcnt vmcnt(0)
ds_write_b128 v125, v[60:63]
v_add3_u32 v10, v60, v61, v62
v_add3_u32 v10, v10, v63, s48
v_xad_u32 v11, v10, v136, v11
v_cmp_ne_u32 vcc, 0, v11
s_cbranch_vccnz BGR_21
BGK_22:
v_cvt_pk_bf16_f32 v64, v64, v65
v_cvt_pk_bf16_f32 v65, v66, v67
ds_write_b64 v124, v[64:65]
v_mov_b32 v18, 9
ds_write_b32 v8, v18
ds_read_b32 v19, v9 offset:0
BS_23:
s_waitcnt lgkmcnt(0)
v_cmp_gt_u32 vcc, 9, v19
s_cbranch_vccz BD_24
ds_read_b32 v19, v9 offset:0
s_add_u32 s49, s49, 1
s_cmp_lt_u32 s49, 131072
s_cbranch_scc1 BS_23
BD_24:
ds_read_b128 v[28:31], v126 offset:0
ds_read_b128 v[32:35], v127 offset:0
ds_read_b128 v[36:39], v126 offset:2048
ds_read_b128 v[40:43], v127 offset:2048
s_waitcnt lgkmcnt(3)
v_mfma_f32_32x32x16_bf16 v[84:99], v[28:31], v[68:71], 0
s_waitcnt lgkmcnt(2)
v_mfma_f32_32x32x16_bf16 v[84:99], v[32:35], v[72:75], v[84:99]
s_waitcnt lgkmcnt(1)
v_mfma_f32_32x32x16_bf16 v[100:115], v[36:39], v[76:79], 0
s_waitcnt lgkmcnt(0)
v_mfma_f32_32x32x16_bf16 v[100:115], v[40:43], v[80:83], v[100:115]
ds_read_b64_tr_b16 v[132:133], v116 offset:0
ds_read_b64_tr_b16 v[134:135], v116 offset:1024
ds_read_b64_tr_b16 v[128:129], v6 offset:0
ds_read_b64_tr_b16 v[130:131], v6 offset:1024
ds_read_b64_tr_b16 v[140:141], v116 offset:4096
ds_read_b64_tr_b16 v[142:143], v116 offset:5120
ds_read_b64_tr_b16 v[136:137], v6 offset:4096
ds_read_b64_tr_b16 v[138:139], v6 offset:5120
ds_read_b64_tr_b16 v[148:149], v116 offset:8192
ds_read_b64_tr_b16 v[150:151], v116 offset:9216
ds_read_b64_tr_b16 v[144:145], v6 offset:8192
ds_read_b64_tr_b16 v[146:147], v6 offset:9216
ds_read_b64_tr_b16 v[156:157], v116 offset:12288
ds_read_b64_tr_b16 v[158:159], v116 offset:13312
ds_read_b64_tr_b16 v[152:153], v6 offset:12288
ds_read_b64_tr_b16 v[154:155], v6 offset:13312
v_pk_add_f32 v[92:93], v[92:93], v[94:95]
v_pk_add_f32 v[96:97], v[96:97], v[98:99]
v_pk_add_f32 v[92:93], v[92:93], v[96:97]
v_add_f32 v92, v92, v93
v_pk_add_f32 v[108:109], v[108:109], v[110:111]
v_pk_add_f32 v[112:113], v[112:113], v[114:115]
v_pk_add_f32 v[108:109], v[108:109], v[112:113]
v_add_f32 v108, v108, v109
s_nop 1
v_permlane32_swap_b32 v92, v108
v_add_f32 v92, v92, v108
v_add_f32 v92, s36, v92
v_rcp_f32 v92, v92
s_nop 0
v_mul_f32 v92, v92, v1
v_mov_b32 v108, v92
s_nop 1
v_permlane32_swap_b32 v92, v108
v_pk_mul_f32 v[84:85], v[84:85], v[92:93] op_sel_hi:[1,0]
v_pk_mul_f32 v[86:87], v[86:87], v[92:93] op_sel_hi:[1,0]
v_pk_mul_f32 v[88:89], v[88:89], v[92:93] op_sel_hi:[1,0]
v_pk_mul_f32 v[90:91], v[90:91], v[92:93] op_sel_hi:[1,0]
v_cvt_pk_bf16_f32 v84, v84, v85
v_cvt_pk_bf16_f32 v85, v86, v87
v_cvt_pk_bf16_f32 v86, v88, v89
v_cvt_pk_bf16_f32 v87, v90, v91
buffer_store_dwordx4 v[84:87], v17, s[12:15], s34 offen offset:0 sc1
v_pk_mul_f32 v[100:101], v[100:101], v[108:109] op_sel_hi:[1,0]
v_pk_mul_f32 v[102:103], v[102:103], v[108:109] op_sel_hi:[1,0]
v_pk_mul_f32 v[104:105], v[104:105], v[108:109] op_sel_hi:[1,0]
v_pk_mul_f32 v[106:107], v[106:107], v[108:109] op_sel_hi:[1,0]
v_cvt_pk_bf16_f32 v100, v100, v101
v_cvt_pk_bf16_f32 v101, v102, v103
v_cvt_pk_bf16_f32 v102, v104, v105
v_cvt_pk_bf16_f32 v103, v106, v107
v_add3_u32 v10, v84, v85, v86
v_add3_u32 v10, v10, v87, v100
v_add3_u32 v10, v10, v101, v102
v_add3_u32 v10, v10, v103, s48
buffer_store_dwordx4 v[100:103], v17, s[12:15], s34 offen offset:1024 sc1
buffer_store_dword v10, v15, s[12:15], s39 offen sc1
s_lshr_b32 s27, s25, 3
s_lshl_b32 s27, s27, 1
s_lshr_b32 s28, s26, 1
s_add_u32 s27, s27, s28
s_lshl_b32 s27, s27, 7
s_add_u32 s28, s27, 118272
v_and_b32 v11, 31, v0
v_lshlrev_b32 v4, 2, v11
v_add_u32 v2, s28, v4
ds_read_b32 v2, v2
v_lshrrev_b32 v12, 5, v0
v_lshl_add_u32 v4, v12, 16, v4
s_lshl_b32 s28, s24, 9
s_add_u32 s16, s27, s28
s_and_b32 s27, s25, 7
s_lshl_b32 s27, s27, 18
s_add_u32 s16, s16, s27
s_and_b32 s27, s26, 1
s_lshl_b32 s27, s27, 17
s_add_u32 s16, s16, s27
s_add_u32 s16, s16, 8650752
s_lshr_b32 s52, s16, 2
s_add_u32 s52, s52, 12582912
s_add_u32 s53, s52, 8192
v_and_b32 v5, 28, v0
v_lshl_add_u32 v5, v12, 14, v5
v_and_b32 v13, 3, v0
v_lshl_add_u32 v5, v13, 11, v5
s_add_u32 s17, s16, 8192
s_add_u32 s18, s17, 8192
s_add_u32 s19, s18, 8192
s_add_u32 s20, s19, 8192
s_add_u32 s21, s20, 8192
s_add_u32 s22, s21, 8192
s_add_u32 s23, s22, 8192
ds_read_b64_tr_b16 v[164:165], v116 offset:2048
ds_read_b64_tr_b16 v[166:167], v116 offset:3072
ds_read_b64_tr_b16 v[160:161], v6 offset:2048
ds_read_b64_tr_b16 v[162:163], v6 offset:3072
ds_read_b64_tr_b16 v[172:173], v116 offset:6144
ds_read_b64_tr_b16 v[174:175], v116 offset:7168
ds_read_b64_tr_b16 v[168:169], v6 offset:6144
ds_read_b64_tr_b16 v[170:171], v6 offset:7168
ds_read_b64_tr_b16 v[180:181], v116 offset:10240
ds_read_b64_tr_b16 v[182:183], v116 offset:11264
ds_read_b64_tr_b16 v[176:177], v6 offset:10240
ds_read_b64_tr_b16 v[178:179], v6 offset:11264
ds_read_b64_tr_b16 v[188:189], v116 offset:14336
ds_read_b64_tr_b16 v[190:191], v116 offset:15360
ds_read_b64_tr_b16 v[184:185], v6 offset:14336
ds_read_b64_tr_b16 v[186:187], v6 offset:15360
ds_read_b64_tr_b16 v[196:197], v117 offset:0
ds_read_b64_tr_b16 v[198:199], v117 offset:1024
ds_read_b64_tr_b16 v[192:193], v7 offset:0
ds_read_b64_tr_b16 v[194:195], v7 offset:1024
ds_read_b64_tr_b16 v[204:205], v117 offset:4096
ds_read_b64_tr_b16 v[206:207], v117 offset:5120
ds_read_b64_tr_b16 v[200:201], v7 offset:4096
ds_read_b64_tr_b16 v[202:203], v7 offset:5120
ds_read_b64_tr_b16 v[212:213], v117 offset:8192
ds_read_b64_tr_b16 v[214:215], v117 offset:9216
ds_read_b64_tr_b16 v[208:209], v7 offset:8192
ds_read_b64_tr_b16 v[210:211], v7 offset:9216
ds_read_b64_tr_b16 v[220:221], v117 offset:12288
ds_read_b64_tr_b16 v[222:223], v117 offset:13312
ds_read_b64_tr_b16 v[216:217], v7 offset:12288
ds_read_b64_tr_b16 v[218:219], v7 offset:13312
ds_read_b64_tr_b16 v[228:229], v117 offset:2048
ds_read_b64_tr_b16 v[230:231], v117 offset:3072
ds_read_b64_tr_b16 v[224:225], v7 offset:2048
ds_read_b64_tr_b16 v[226:227], v7 offset:3072
ds_read_b64_tr_b16 v[236:237], v117 offset:6144
ds_read_b64_tr_b16 v[238:239], v117 offset:7168
ds_read_b64_tr_b16 v[232:233], v7 offset:6144
ds_read_b64_tr_b16 v[234:235], v7 offset:7168
ds_read_b64_tr_b16 v[244:245], v117 offset:10240
ds_read_b64_tr_b16 v[246:247], v117 offset:11264
ds_read_b64_tr_b16 v[240:241], v7 offset:10240
ds_read_b64_tr_b16 v[242:243], v7 offset:11264
ds_read_b64_tr_b16 v[252:253], v117 offset:14336
ds_read_b64_tr_b16 v[254:255], v117 offset:15360
ds_read_b64_tr_b16 v[248:249], v7 offset:14336
ds_read_b64_tr_b16 v[250:251], v7 offset:15360
s_add_u32 s27, s31, 49152
v_add_u32 v16, s27, v17
v_xor_b32 v3, 0x1000, v16
v_lshlrev_b32 v12, 5, v12
v_lshl_add_u32 v14, v11, 10, v12
s_lshl_b32 s27, s48, 1
s_sub_u32 s63, 0, s27
s_xor_b32 s27, s26, 1
s_lshl_b32 s27, s27, 4
s_lshl_b64 s[54:55], 1, s27
s_add_u32 s27, s31, 49152
s_xor_b32 s27, s27, 0x1000
v_lshrrev_b32 v13, 1, v0
v_and_b32 v13, 3, v13
v_lshrrev_b32 v6, 4, v12
v_xor_b32 v6, v6, v13
v_lshlrev_b32 v6, 4, v6
v_lshl_add_u32 v6, v11, 6, v6
v_add_u32 v6, s27, v6
v_xor_b32 v7, 16, v6
v_lshrrev_b32 v13, 3, v0
v_xor_b32 v13, v13, v0
v_and_b32 v13, 3, v13
v_lshrrev_b32 v12, 2, v0
v_lshlrev_b32 v14, 10, v12
v_lshlrev_b32 v12, 6, v12
v_lshl_add_u32 v12, v13, 4, v12
v_add_u32 v12, s27, v12
v_and_b32 v13, 3, v0
v_lshl_add_u32 v14, v13, 4, v14
s_add_u32 s62, s60, 16384
s_waitcnt lgkmcnt(0)
v_sub_f32 v2, 1.0, v2
s_sleep 11
buffer_load_dword v118, v15, s[12:15], s61 offen offset:0 sc1
buffer_load_dwordx4 v[20:23], v17, s[12:15], s56 offen offset:0 sc1
buffer_load_dwordx4 v[24:27], v17, s[12:15], s56 offen offset:1024 sc1
buffer_load_dword v119, v15, s[12:15], s61 offen offset:512 sc1
buffer_load_dwordx4 v[28:31], v17, s[12:15], s56 offen offset:2048 sc1
buffer_load_dwordx4 v[32:35], v17, s[12:15], s56 offen offset:3072 sc1
buffer_load_dword v120, v15, s[12:15], s61 offen offset:1024 sc1
buffer_load_dwordx4 v[36:39], v17, s[12:15], s57 offen offset:0 sc1
buffer_load_dwordx4 v[40:43], v17, s[12:15], s57 offen offset:1024 sc1
buffer_load_dword v121, v15, s[12:15], s61 offen offset:1536 sc1
buffer_load_dwordx4 v[44:47], v17, s[12:15], s57 offen offset:2048 sc1
buffer_load_dwordx4 v[48:51], v17, s[12:15], s57 offen offset:3072 sc1
s_waitcnt lgkmcnt(0)
s_mov_b32 s51, 0
s_waitcnt vmcnt(9)
v_add3_u32 v10, v20, v21, v22
v_add3_u32 v10, v10, v23, v24
v_add3_u32 v10, v10, v25, v26
v_add3_u32 v10, v10, v27, s48
v_cmp_ne_u32 vcc, v10, v118
s_cbranch_vccnz BHR_25
BHK_26:
v_mfma_f32_32x32x16_bf16 v[100:115], v[132:135], v[20:23], 0
buffer_load_dword v122, v15, s[12:15], s61 offen offset:2048 sc1
buffer_load_dwordx4 v[52:55], v17, s[12:15], s58 offen offset:0 sc1
v_mfma_f32_32x32x16_bf16 v[84:99], v[128:131], v[20:23], 0
buffer_load_dwordx4 v[56:59], v17, s[12:15], s58 offen offset:1024 sc1
buffer_load_dword v123, v15, s[12:15], s61 offen offset:2560 sc1
s_waitcnt vmcnt(10)
v_add3_u32 v10, v28, v29, v30
v_add3_u32 v10, v10, v31, v32
v_add3_u32 v10, v10, v33, v34
v_add3_u32 v10, v10, v35, s48
v_cmp_ne_u32 vcc, v10, v119
v_mfma_f32_32x32x16_bf16 v[100:115], v[140:143], v[24:27], v[100:115]
buffer_load_dwordx4 v[60:63], v17, s[12:15], s58 offen offset:2048 sc1
buffer_load_dwordx4 v[64:67], v17, s[12:15], s58 offen offset:3072 sc1
v_mfma_f32_32x32x16_bf16 v[84:99], v[136:139], v[24:27], v[84:99]
buffer_load_dword v124, v15, s[12:15], s61 offen offset:3072 sc1
buffer_load_dwordx4 v[68:71], v17, s[12:15], s59 offen offset:0 sc1
s_cbranch_vccnz BHR_27
BHK_28:
v_mfma_f32_32x32x16_bf16 v[100:115], v[148:151], v[28:31], v[100:115]
buffer_load_dwordx4 v[72:75], v17, s[12:15], s59 offen offset:1024 sc1
buffer_load_dword v125, v15, s[12:15], s61 offen offset:3584 sc1
v_mfma_f32_32x32x16_bf16 v[84:99], v[144:147], v[28:31], v[84:99]
buffer_load_dwordx4 v[76:79], v17, s[12:15], s59 offen offset:2048 sc1
buffer_load_dwordx4 v[80:83], v17, s[12:15], s59 offen offset:3072 sc1
s_waitcnt vmcnt(15)
v_add3_u32 v10, v36, v37, v38
v_add3_u32 v10, v10, v39, v40
v_add3_u32 v10, v10, v41, v42
v_add3_u32 v10, v10, v43, s48
v_cmp_ne_u32 vcc, v10, v120
v_mfma_f32_32x32x16_bf16 v[100:115], v[156:159], v[32:35], v[100:115]
v_mfma_f32_32x32x16_bf16 v[84:99], v[152:155], v[32:35], v[84:99]
s_cbranch_vccnz BHR_29
BHK_30:
v_mfma_f32_32x32x16_bf16 v[100:115], v[164:167], v[36:39], v[100:115]
v_mfma_f32_32x32x16_bf16 v[84:99], v[160:163], v[36:39], v[84:99]
s_waitcnt vmcnt(12)
v_add3_u32 v10, v44, v45, v46
v_add3_u32 v10, v10, v47, v48
v_add3_u32 v10, v10, v49, v50
v_add3_u32 v10, v10, v51, s48
v_cmp_ne_u32 vcc, v10, v121
v_mfma_f32_32x32x16_bf16 v[100:115], v[172:175], v[40:43], v[100:115]
v_mfma_f32_32x32x16_bf16 v[84:99], v[168:171], v[40:43], v[84:99]
s_cbranch_vccnz BHR_31
BHK_32:
v_mfma_f32_32x32x16_bf16 v[100:115], v[180:183], v[44:47], v[100:115]
v_mfma_f32_32x32x16_bf16 v[84:99], v[176:179], v[44:47], v[84:99]
s_waitcnt vmcnt(9)
v_add3_u32 v10, v52, v53, v54
v_add3_u32 v10, v10, v55, v56
v_add3_u32 v10, v10, v57, v58
v_add3_u32 v10, v10, v59, s48
v_cmp_ne_u32 vcc, v10, v122
v_mfma_f32_32x32x16_bf16 v[100:115], v[188:191], v[48:51], v[100:115]
v_mfma_f32_32x32x16_bf16 v[84:99], v[184:187], v[48:51], v[84:99]
s_cbranch_vccnz BHR_33
BHK_34:
v_mfma_f32_32x32x16_bf16 v[100:115], v[196:199], v[52:55], v[100:115]
buffer_load_dword v28, v5, s[12:15], s52 offen sc1
buffer_load_dword v29, v5, s[12:15], s53 offen sc1
buffer_load_dword v20, v4, s[12:15], s16 offen sc1
buffer_load_dword v21, v4, s[12:15], s17 offen sc1
buffer_load_dword v22, v4, s[12:15], s18 offen sc1
buffer_load_dword v23, v4, s[12:15], s19 offen sc1
buffer_load_dword v24, v4, s[12:15], s20 offen sc1
buffer_load_dword v25, v4, s[12:15], s21 offen sc1
buffer_load_dword v26, v4, s[12:15], s22 offen sc1
buffer_load_dword v27, v4, s[12:15], s23 offen sc1
v_mfma_f32_32x32x16_bf16 v[84:99], v[192:195], v[52:55], v[84:99]
s_waitcnt vmcnt(16)
v_add3_u32 v10, v60, v61, v62
v_add3_u32 v10, v10, v63, v64
v_add3_u32 v10, v10, v65, v66
v_add3_u32 v10, v10, v67, s48
v_cmp_ne_u32 vcc, v10, v123
v_mfma_f32_32x32x16_bf16 v[100:115], v[204:207], v[56:59], v[100:115]
v_mfma_f32_32x32x16_bf16 v[84:99], v[200:203], v[56:59], v[84:99]
s_cbranch_vccnz BHR_35
BHK_36:
v_mfma_f32_32x32x16_bf16 v[100:115], v[212:215], v[60:63], v[100:115]
v_mfma_f32_32x32x16_bf16 v[84:99], v[208:211], v[60:63], v[84:99]
s_waitcnt vmcnt(13)
v_add3_u32 v10, v68, v69, v70
v_add3_u32 v10, v10, v71, v72
v_add3_u32 v10, v10, v73, v74
v_add3_u32 v10, v10, v75, s48
v_cmp_ne_u32 vcc, v10, v124
v_mfma_f32_32x32x16_bf16 v[100:115], v[220:223], v[64:67], v[100:115]
v_mfma_f32_32x32x16_bf16 v[84:99], v[216:219], v[64:67], v[84:99]
s_cbranch_vccnz BHR_37
BHK_38:
v_mfma_f32_32x32x16_bf16 v[100:115], v[228:231], v[68:71], v[100:115]
v_mfma_f32_32x32x16_bf16 v[84:99], v[224:227], v[68:71], v[84:99]
s_waitcnt vmcnt(10)
v_add3_u32 v10, v76, v77, v78
v_add3_u32 v10, v10, v79, v80
v_add3_u32 v10, v10, v81, v82
v_add3_u32 v10, v10, v83, s48
v_cmp_ne_u32 vcc, v10, v125
v_mfma_f32_32x32x16_bf16 v[100:115], v[236:239], v[72:75], v[100:115]
v_mfma_f32_32x32x16_bf16 v[84:99], v[232:235], v[72:75], v[84:99]
s_cbranch_vccnz BHR_39
BHK_40:
v_mfma_f32_32x32x16_bf16 v[100:115], v[244:247], v[76:79], v[100:115]
v_mfma_f32_32x32x16_bf16 v[100:115], v[252:255], v[80:83], v[100:115]
v_mfma_f32_32x32x16_bf16 v[84:99], v[240:243], v[76:79], v[84:99]
s_nop 10
ds_write_b128 v16, v[100:103] offset:0
ds_write_b128 v16, v[104:107] offset:1024
ds_write_b128 v16, v[108:111] offset:2048
ds_write_b128 v16, v[112:115] offset:3072
v_mov_b32 v18, 10
ds_write_b32 v8, v18
ds_read_b32 v19, v9 offset:0
ds_read_b128 v[36:39], v3 offset:0
ds_read_b128 v[40:43], v3 offset:1024
ds_read_b128 v[44:47], v3 offset:2048
ds_read_b128 v[48:51], v3 offset:3072
v_mfma_f32_32x32x16_bf16 v[84:99], v[248:251], v[80:83], v[84:99]
s_waitcnt vmcnt(0)
v_add3_u32 v10, v20, v21, v22
v_add3_u32 v11, v28, v29, s63
v_add3_u32 v10, v10, v23, v24
v_sub_u32 v11, v27, v11
v_add3_u32 v10, v10, v25, v26
v_add_u32 v10, v10, v11
s_nop 1
v_add_u32_dpp v10, v10, v10 quad_perm:[1,0,3,2] row_mask:0xf bank_mask:0xf
s_nop 1
v_add_u32_dpp v10, v10, v10 quad_perm:[2,3,0,1] row_mask:0xf bank_mask:0xf
v_cmp_ne_u32 vcc, 0, v10
v_lshlrev_b32 v52, 16, v20
v_and_b32 v53, 0xffff0000, v20
v_lshlrev_b32 v54, 16, v21
v_and_b32 v55, 0xffff0000, v21
v_lshlrev_b32 v56, 16, v22
v_and_b32 v57, 0xffff0000, v22
v_lshlrev_b32 v58, 16, v23
v_and_b32 v59, 0xffff0000, v23
v_lshlrev_b32 v60, 16, v24
v_and_b32 v61, 0xffff0000, v24
v_lshlrev_b32 v62, 16, v25
v_and_b32 v63, 0xffff0000, v25
v_lshlrev_b32 v64, 16, v26
v_and_b32 v65, 0xffff0000, v26
v_lshlrev_b32 v66, 16, v27
v_and_b32 v67, 0xffff0000, v27
s_cbranch_vccnz BAR_41
BAK_42:
v_pk_fma_f32 v[84:85], v[52:53], v[2:3], v[84:85] op_sel_hi:[1,0,1]
v_pk_fma_f32 v[86:87], v[54:55], v[2:3], v[86:87] op_sel_hi:[1,0,1]
v_pk_fma_f32 v[88:89], v[56:57], v[2:3], v[88:89] op_sel_hi:[1,0,1]
v_pk_fma_f32 v[90:91], v[58:59], v[2:3], v[90:91] op_sel_hi:[1,0,1]
v_pk_fma_f32 v[92:93], v[60:61], v[2:3], v[92:93] op_sel_hi:[1,0,1]
v_pk_fma_f32 v[94:95], v[62:63], v[2:3], v[94:95] op_sel_hi:[1,0,1]
v_pk_fma_f32 v[96:97], v[64:65], v[2:3], v[96:97] op_sel_hi:[1,0,1]
v_pk_fma_f32 v[98:99], v[66:67], v[2:3], v[98:99] op_sel_hi:[1,0,1]
BS_43:
s_waitcnt lgkmcnt(4)
v_cmp_gt_u32 vcc, 10, v19
s_and_b64 vcc, vcc, s[54:55]
s_cbranch_scc0 BD_44
ds_read_b32 v19, v9 offset:0
ds_read_b128 v[36:39], v3 offset:0
ds_read_b128 v[40:43], v3 offset:1024
ds_read_b128 v[44:47], v3 offset:2048
ds_read_b128 v[48:51], v3 offset:3072
s_add_u32 s49, s49, 1
s_cmp_lt_u32 s49, 131072
s_cbranch_scc1 BS_43
BD_44:
s_waitcnt lgkmcnt(2)
v_pk_add_f32 v[84:85], v[84:85], v[36:37]
v_pk_add_f32 v[86:87], v[86:87], v[38:39]
v_pk_add_f32 v[88:89], v[88:89], v[40:41]
v_pk_add_f32 v[90:91], v[90:91], v[42:43]
v_cvt_pk_bf16_f32 v20, v84, v85
v_cvt_pk_bf16_f32 v21, v86, v87
v_cvt_pk_bf16_f32 v22, v88, v89
v_cvt_pk_bf16_f32 v23, v90, v91
s_waitcnt lgkmcnt(0)
v_pk_add_f32 v[92:93], v[92:93], v[44:45]
v_pk_add_f32 v[94:95], v[94:95], v[46:47]
v_pk_add_f32 v[96:97], v[96:97], v[48:49]
v_pk_add_f32 v[98:99], v[98:99], v[50:51]
v_cvt_pk_bf16_f32 v24, v92, v93
v_cvt_pk_bf16_f32 v25, v94, v95
v_cvt_pk_bf16_f32 v26, v96, v97
v_cvt_pk_bf16_f32 v27, v98, v99
ds_write_b128 v6, v[20:23]
ds_write_b128 v7, v[24:27]
ds_read_b128 v[28:31], v12 offset:0
ds_read_b128 v[32:35], v12 offset:1024
s_waitcnt lgkmcnt(1)
buffer_store_dwordx4 v[28:31], v14, s[44:47], s60 offen sc1
s_waitcnt lgkmcnt(0)
buffer_store_dwordx4 v[32:35], v14, s[44:47], s62 offen sc1
s_or_b32 s27, s2, s26
s_cmp_lg_u32 s27, 0
s_cbranch_scc1 BE_45
s_mov_b32 s27, 11665408
v_mov_b32 v41, 0
v_mov_b32 v40, s48
s_mov_b64 exec, 1
buffer_store_dword v40, v41, s[12:15], s27 offen sc1
s_mov_b64 exec, -1
BE_45:
s_endpgm
K_A:
s_lshr_b32 s33, s26, 1
s_and_b32 s30, s26, 1
s_mov_b32 s36, 0x3fb8aa3b
s_mov_b32 s37, 0x32a57060
s_mov_b32 s38, 0x3f317218
s_mov_b32 s49, 0
s_mul_i32 s34, s33, 16640
s_add_u32 s34, s34, 121344
s_mul_i32 s31, s30, 8448
s_add_u32 s31, s31, s34
v_bfe_u32 v7, v0, 4, 1
v_xor_b32 v7, v7, v0
v_lshlrev_b32 v6, 4, v7
v_lshrrev_b32 v7, 4, v0
v_lshlrev_b32 v7, 7, v7
v_and_b32 v8, 31, v0
v_lshl_add_u32 v7, v8, 2, v7
v_add_u32 v57, 116736, v7
v_lshlrev_b32 v60, 4, v0
v_lshrrev_b32 v7, 4, v0
v_bfe_u32 v8, v0, 2, 2
v_lshl_add_u32 v9, v7, 4, v8
v_lshlrev_b32 v9, 7, v9
v_and_b32 v10, 1, v0
v_lshl_add_u32 v9, v10, 3, v9
s_lshr_b32 s27, s25, 3
s_lshl_b32 s27, s27, 1
s_add_u32 s27, s27, s30
s_lshl_b32 s28, s27, 1
v_bfe_u32 v10, v0, 1, 1
v_add_u32 v10, s28, v10
v_bfe_u32 v11, v0, 3, 1
v_xor_b32 v10, v10, v11
v_lshl_add_u32 v9, v10, 4, v9
s_lshl_b32 s28, s33, 13
s_add_u32 s28, s28, 32768
v_add_u32 v80, s28, v9
v_lshlrev_b32 v9, 14, v8
v_lshl_add_u32 v9, v7, 6, v9
v_and_b32 v10, 3, v0
v_lshl_add_u32 v81, v10, 4, v9
s_lshl_b32 s27, s27, 16
s_lshl_b32 s28, s29, 18
s_add_u32 s27, s27, s28
s_lshl_b32 s28, s24, 9
s_add_u32 s27, s27, s28
s_lshl_b32 s28, s33, 8
s_add_u32 s58, s27, s28
s_add_u32 s58, s58, 0
s_add_u32 s59, s58, 8192
s_lshr_b32 s62, s58, 2
s_add_u32 s62, s62, 12582912
v_lshrrev_b32 v82, 2, v81
s_lshl_b32 s27, s50, 13
s_lshl_b32 s28, s26, 11
s_add_u32 s27, s27, s28
s_add_u32 s55, s27, 8650752
s_add_u32 s57, s27, 0
s_lshr_b32 s54, s55, 2
s_add_u32 s54, s54, 12582912
s_lshr_b32 s56, s57, 2
s_add_u32 s56, s56, 12582912
v_and_b32 v7, 7, v0
v_lshlrev_b32 v7, 4, v7
v_lshl_add_u32 v7, v0, 7, v7
v_add_u32 v24, s31, v7
v_lshrrev_b32 v7, 5, v0
v_bfe_u32 v12, v0, 3, 1
v_lshl_add_u32 v7, v7, 2, v12
v_bfe_u32 v12, v0, 2, 1
v_bfe_u32 v13, v0, 4, 1
v_lshlrev_b32 v13, 1, v13
v_lshl_add_u32 v12, v12, 2, v13
v_bfe_u32 v13, v0, 1, 1
v_add_u32 v12, v12, v13
v_xor_b32 v12, v12, v7
v_lshlrev_b32 v12, 4, v12
v_lshl_add_u32 v12, v7, 7, v12
v_and_b32 v13, 1, v0
v_lshl_add_u32 v12, v13, 3, v12
v_add_u32 v25, s31, v12
v_xor_b32 v12, 32, v12
v_add_u32 v26, s31, v12
s_waitcnt lgkmcnt(0)
s_lshl_b32 s27, s33, 4
s_lshr_b32 s20, s20, s27
s_lshl_b32 s20, s20, 16
s_lshr_b32 s21, s21, s27
s_lshl_b32 s21, s21, 16
v_mov_b32 v7, s20
v_mul_f32 v12, s36, v7
v_fma_f32 v13, v7, s36, -v12
v_fma_f32 v13, v7, s37, v13
v_exp_f32 v27, v12
v_mul_f32 v13, s38, v13
v_fma_f32 v27, v27, v13, v27
v_cvt_pk_bf16_f32 v27, v27, v27
v_and_b32 v27, 0xffff0000, v27
s_waitcnt vmcnt(1)
v_lshlrev_b32 v2, 16, v2
v_lshlrev_b32 v3, 16, v3
v_lshlrev_b32 v4, 16, v4
v_lshlrev_b32 v5, 16, v5
v_mul_f32 v12, s36, v2
v_fma_f32 v13, v2, s36, -v12
v_fma_f32 v13, v2, s37, v13
v_exp_f32 v2, v12
v_mul_f32 v13, s38, v13
v_fma_f32 v2, v2, v13, v2
v_cvt_pk_bf16_f32 v2, v2, v2
v_and_b32 v2, 0xffff0000, v2
v_mul_f32 v2, v2, v27
v_mul_f32 v3, v3, v27
v_mul_f32 v2, s36, v2
v_mul_f32 v3, 0.15915494, v3
v_mul_f32 v4, v4, v27
v_mul_f32 v5, v5, v27
v_add_f32 v20, v4, v4
v_add_f32 v21, v5, v5
v_mul_f32 v22, 0xc1000000, v2
v_mul_f32 v23, 0x41000000, v3
v_exp_f32 v22, v22
v_fract_f32 v23, v23
v_cos_f32 v14, v23
v_sin_f32 v15, v23
v_mul_f32 v14, v14, v22
v_mul_f32 v15, v15, v22
v_mov_b32 v32, 1.0
v_mov_b32 v33, 0
v_mov_b32 v34, v14
v_mov_b32 v35, v15
v_mul_f32 v36, v34, v14
v_mul_f32 v37, v34, v15
v_fma_f32 v36, -v35, v15, v36
v_fmac_f32 v37, v35, v14
v_mul_f32 v38, v36, v14
v_mul_f32 v39, v36, v15
v_fma_f32 v38, -v37, v15, v38
v_fmac_f32 v39, v37, v14
v_mul_f32 v40, v38, v14
v_mul_f32 v41, v38, v15
v_fma_f32 v40, -v39, v15, v40
v_fmac_f32 v41, v39, v14
v_mul_f32 v42, v40, v14
v_mul_f32 v43, v40, v15
v_fma_f32 v42, -v41, v15, v42
v_fmac_f32 v43, v41, v14
v_mul_f32 v44, v42, v14
v_mul_f32 v45, v42, v15
v_fma_f32 v44, -v43, v15, v44
v_fmac_f32 v45, v43, v14
v_mul_f32 v46, v44, v14
v_mul_f32 v47, v44, v15
v_fma_f32 v46, -v45, v15, v46
v_fmac_f32 v47, v45, v14
v_cvt_pk_bf16_f32 v48, v32, v34
v_cvt_pk_bf16_f32 v49, v36, v38
v_cvt_pk_bf16_f32 v50, v40, v42
v_cvt_pk_bf16_f32 v51, v44, v46
v_cvt_pk_bf16_f32 v52, v33, v35
v_cvt_pk_bf16_f32 v53, v37, v39
v_cvt_pk_bf16_f32 v54, v41, v43
v_cvt_pk_bf16_f32 v55, v45, v47
ds_write_b128 v24, v[48:51]
v_xor_b32 v29, 64, v24
ds_write_b128 v29, v[52:55]
v_mul_f32 v32, v46, v14
v_mul_f32 v33, v46, v15
v_fma_f32 v32, -v47, v15, v32
v_fmac_f32 v33, v47, v14
v_mul_f32 v34, v32, v14
v_mul_f32 v35, v32, v15
v_fma_f32 v34, -v33, v15, v34
v_fmac_f32 v35, v33, v14
v_mul_f32 v36, v34, v14
v_mul_f32 v37, v34, v15
v_fma_f32 v36, -v35, v15, v36
v_fmac_f32 v37, v35, v14
v_mul_f32 v38, v36, v14
v_mul_f32 v39, v36, v15
v_fma_f32 v38, -v37, v15, v38
v_fmac_f32 v39, v37, v14
v_mul_f32 v40, v38, v14
v_mul_f32 v41, v38, v15
v_fma_f32 v40, -v39, v15, v40
v_fmac_f32 v41, v39, v14
v_mul_f32 v42, v40, v14
v_mul_f32 v43, v40, v15
v_fma_f32 v42, -v41, v15, v42
v_fmac_f32 v43, v41, v14
v_mul_f32 v44, v42, v14
v_mul_f32 v45, v42, v15
v_fma_f32 v44, -v43, v15, v44
v_fmac_f32 v45, v43, v14
v_mul_f32 v46, v44, v14
v_mul_f32 v47, v44, v15
v_fma_f32 v46, -v45, v15, v46
v_fmac_f32 v47, v45, v14
v_cvt_pk_bf16_f32 v48, v32, v34
v_cvt_pk_bf16_f32 v49, v36, v38
v_cvt_pk_bf16_f32 v50, v40, v42
v_cvt_pk_bf16_f32 v51, v44, v46
v_cvt_pk_bf16_f32 v52, v33, v35
v_cvt_pk_bf16_f32 v53, v37, v39
v_cvt_pk_bf16_f32 v54, v41, v43
v_cvt_pk_bf16_f32 v55, v45, v47
v_xor_b32 v28, 16, v24
ds_write_b128 v28, v[48:51]
v_xor_b32 v29, 80, v24
ds_write_b128 v29, v[52:55]
s_barrier
ds_read_b64_tr_b16 v[64:65], v80 offset:0
v_xor_b32 v83, 32, v80
ds_read_b64_tr_b16 v[66:67], v83 offset:512
v_xor_b32 v83, 64, v80
ds_read_b64_tr_b16 v[68:69], v83 offset:1024
v_xor_b32 v83, 96, v80
ds_read_b64_tr_b16 v[70:71], v83 offset:1536
v_mul_f32 v32, v46, v14
v_mul_f32 v33, v46, v15
v_fma_f32 v32, -v47, v15, v32
v_fmac_f32 v33, v47, v14
v_mul_f32 v34, v32, v14
v_mul_f32 v35, v32, v15
v_fma_f32 v34, -v33, v15, v34
v_fmac_f32 v35, v33, v14
v_mul_f32 v36, v34, v14
v_mul_f32 v37, v34, v15
v_fma_f32 v36, -v35, v15, v36
v_fmac_f32 v37, v35, v14
v_mul_f32 v38, v36, v14
v_mul_f32 v39, v36, v15
v_fma_f32 v38, -v37, v15, v38
v_fmac_f32 v39, v37, v14
v_mul_f32 v40, v38, v14
v_mul_f32 v41, v38, v15
v_fma_f32 v40, -v39, v15, v40
v_fmac_f32 v41, v39, v14
v_mul_f32 v42, v40, v14
v_mul_f32 v43, v40, v15
v_fma_f32 v42, -v41, v15, v42
v_fmac_f32 v43, v41, v14
v_mul_f32 v44, v42, v14
v_mul_f32 v45, v42, v15
v_fma_f32 v44, -v43, v15, v44
v_fmac_f32 v45, v43, v14
v_mul_f32 v46, v44, v14
v_mul_f32 v47, v44, v15
v_fma_f32 v46, -v45, v15, v46
v_fmac_f32 v47, v45, v14
v_cvt_pk_bf16_f32 v48, v32, v34
v_cvt_pk_bf16_f32 v49, v36, v38
v_cvt_pk_bf16_f32 v50, v40, v42
v_cvt_pk_bf16_f32 v51, v44, v46
v_cvt_pk_bf16_f32 v52, v33, v35
v_cvt_pk_bf16_f32 v53, v37, v39
v_cvt_pk_bf16_f32 v54, v41, v43
v_cvt_pk_bf16_f32 v55, v45, v47
v_xor_b32 v28, 32, v24
ds_write_b128 v28, v[48:51]
v_xor_b32 v29, 96, v24
ds_write_b128 v29, v[52:55]
s_waitcnt lgkmcnt(2)
s_mov_b32 vcc_lo, 0x33333333
s_mov_b32 vcc_hi, 0x33333333
v_cndmask_b32_dpp v72, v68, v64, vcc quad_perm:[2,3,0,1] row_mask:0xf bank_mask:0xf
v_cndmask_b32_dpp v73, v69, v65, vcc quad_perm:[2,3,0,1] row_mask:0xf bank_mask:0xf
v_cndmask_b32_dpp v74, v70, v66, vcc quad_perm:[2,3,0,1] row_mask:0xf bank_mask:0xf
v_cndmask_b32_dpp v75, v71, v67, vcc quad_perm:[2,3,0,1] row_mask:0xf bank_mask:0xf
s_not_b64 vcc, vcc
v_cndmask_b32_dpp v76, v64, v68, vcc quad_perm:[2,3,0,1] row_mask:0xf bank_mask:0xf
v_cndmask_b32_dpp v77, v65, v69, vcc quad_perm:[2,3,0,1] row_mask:0xf bank_mask:0xf
v_cndmask_b32_dpp v78, v66, v70, vcc quad_perm:[2,3,0,1] row_mask:0xf bank_mask:0xf
v_cndmask_b32_dpp v79, v67, v71, vcc quad_perm:[2,3,0,1] row_mask:0xf bank_mask:0xf
s_waitcnt vmcnt(0)
v_readfirstlane_b32 s48, v62
v_mov_b32 v63, 118784
s_mul_i32 s48, s48, 0x41c64e6d
s_add_u32 s48, s48, 0x3039
s_or_b32 s48, s48, 1
v_mov_b32 v62, s48
ds_write_b32 v63, v62
v_mov_b32 v58, 1
ds_write_b32 v56, v58
v_add3_u32 v84, v72, v73, v74
v_add3_u32 v84, v84, v75, s48
v_add3_u32 v85, v76, v77, v78
v_add3_u32 v85, v85, v79, s48
s_setprio 3
buffer_store_dwordx4 v[72:75], v81, s[12:15], s58 offen sc1
buffer_store_dwordx4 v[76:79], v81, s[12:15], s59 offen sc1
buffer_store_dword v84, v82, s[12:15], s62 offen sc1
buffer_store_dword v85, v82, s[12:15], s62 offen offset:2048 sc1
s_setprio 0
v_mul_f32 v32, v46, v14
v_mul_f32 v33, v46, v15
v_fma_f32 v32, -v47, v15, v32
v_fmac_f32 v33, v47, v14
v_mul_f32 v34, v32, v14
v_mul_f32 v35, v32, v15
v_fma_f32 v34, -v33, v15, v34
v_fmac_f32 v35, v33, v14
v_mul_f32 v36, v34, v14
v_mul_f32 v37, v34, v15
v_fma_f32 v36, -v35, v15, v36
v_fmac_f32 v37, v35, v14
v_mul_f32 v38, v36, v14
v_mul_f32 v39, v36, v15
v_fma_f32 v38, -v37, v15, v38
v_fmac_f32 v39, v37, v14
v_mul_f32 v40, v38, v14
v_mul_f32 v41, v38, v15
v_fma_f32 v40, -v39, v15, v40
v_fmac_f32 v41, v39, v14
v_mul_f32 v42, v40, v14
v_mul_f32 v43, v40, v15
v_fma_f32 v42, -v41, v15, v42
v_fmac_f32 v43, v41, v14
v_mul_f32 v44, v42, v14
v_mul_f32 v45, v42, v15
v_fma_f32 v44, -v43, v15, v44
v_fmac_f32 v45, v43, v14
v_mul_f32 v46, v44, v14
v_mul_f32 v47, v44, v15
v_fma_f32 v46, -v45, v15, v46
v_fmac_f32 v47, v45, v14
v_cvt_pk_bf16_f32 v48, v32, v34
v_cvt_pk_bf16_f32 v49, v36, v38
v_cvt_pk_bf16_f32 v50, v40, v42
v_cvt_pk_bf16_f32 v51, v44, v46
v_cvt_pk_bf16_f32 v52, v33, v35
v_cvt_pk_bf16_f32 v53, v37, v39
v_cvt_pk_bf16_f32 v54, v41, v43
v_cvt_pk_bf16_f32 v55, v45, v47
v_xor_b32 v28, 48, v24
ds_write_b128 v28, v[48:51]
v_xor_b32 v29, 112, v24
ds_write_b128 v29, v[52:55]
ds_read_b64_tr_b16 v[128:129], v25 offset:0
ds_read_b64_tr_b16 v[130:131], v26 offset:256
ds_read_b64_tr_b16 v[132:133], v25 offset:1024
ds_read_b64_tr_b16 v[134:135], v26 offset:1280
ds_read_b64_tr_b16 v[136:137], v25 offset:2048
ds_read_b64_tr_b16 v[138:139], v26 offset:2304
ds_read_b64_tr_b16 v[140:141], v25 offset:3072
ds_read_b64_tr_b16 v[142:143], v26 offset:3328
ds_read_b64_tr_b16 v[144:145], v25 offset:4096
ds_read_b64_tr_b16 v[146:147], v26 offset:4352
ds_read_b64_tr_b16 v[148:149], v25 offset:5120
ds_read_b64_tr_b16 v[150:151], v26 offset:5376
ds_read_b64_tr_b16 v[152:153], v25 offset:6144
ds_read_b64_tr_b16 v[154:155], v26 offset:6400
ds_read_b64_tr_b16 v[156:157], v25 offset:7168
ds_read_b64_tr_b16 v[158:159], v26 offset:7424
v_exp_f32 v22, -v2
v_fract_f32 v23, v3
v_cos_f32 v8, v23
v_sin_f32 v9, v23
v_mul_f32 v8, v8, v22
v_mul_f32 v9, v9, v22
v_mul_f32 v22, 0xc3800000, v2
v_mul_f32 v23, 0x43800000, v3
v_exp_f32 v22, v22
v_fract_f32 v23, v23
v_cos_f32 v16, v23
v_sin_f32 v17, v23
v_mul_f32 v16, v16, v22
v_mul_f32 v17, v17, v22
v_mul_f32 v10, v8, v8
v_mul_f32 v11, v8, v9
v_fma_f32 v10, -v9, v9, v10
v_fmac_f32 v11, v9, v8
v_mul_f32 v12, v10, v10
v_mul_f32 v13, v10, v11
v_fma_f32 v12, -v11, v11, v12
v_fmac_f32 v13, v11, v10
v_mul_f32 v34, v20, v8
v_mul_f32 v35, v20, v9
v_fma_f32 v34, -v21, v9, v34
v_fmac_f32 v35, v21, v8
v_mul_f32 v36, v34, v8
v_mul_f32 v37, v34, v9
v_fma_f32 v36, -v35, v9, v36
v_fmac_f32 v37, v35, v8
v_mul_f32 v38, v36, v8
v_mul_f32 v39, v36, v9
v_fma_f32 v38, -v37, v9, v38
v_fmac_f32 v39, v37, v8
v_mul_f32 v40, v38, v8
v_mul_f32 v41, v38, v9
v_fma_f32 v40, -v39, v9, v40
v_fmac_f32 v41, v39, v8
v_mul_f32 v42, v40, v8
v_mul_f32 v43, v40, v9
v_fma_f32 v42, -v41, v9, v42
v_fmac_f32 v43, v41, v8
v_mul_f32 v44, v42, v8
v_mul_f32 v45, v42, v9
v_fma_f32 v44, -v43, v9, v44
v_fmac_f32 v45, v43, v8
v_mul_f32 v46, v44, v8
v_mul_f32 v47, v44, v9
v_fma_f32 v46, -v45, v9, v46
v_fmac_f32 v47, v45, v8
s_waitcnt lgkmcnt(0)
v_cvt_pk_bf16_f32 v48, v20, v34
v_cvt_pk_bf16_f32 v49, v36, v38
v_cvt_pk_bf16_f32 v50, v40, v42
v_cvt_pk_bf16_f32 v51, v44, v46
v_cvt_pk_bf16_f32 v52, -v21, -v35
v_cvt_pk_bf16_f32 v53, -v37, -v39
v_cvt_pk_bf16_f32 v54, -v41, -v43
v_cvt_pk_bf16_f32 v55, -v45, -v47
ds_write_b128 v24, v[48:51]
v_xor_b32 v29, 64, v24
ds_write_b128 v29, v[52:55]
v_mul_f32 v32, v20, v16
v_mul_f32 v33, v20, v17
v_fma_f32 v32, -v21, v17, v32
v_fmac_f32 v33, v21, v16
v_mul_f32 v34, v32, v10
v_mul_f32 v35, v32, v11
v_fma_f32 v34, -v33, v11, v34
v_fmac_f32 v35, v33, v10
v_mul_f32 v36, v34, v10
v_mul_f32 v37, v34, v11
v_fma_f32 v36, -v35, v11, v36
v_fmac_f32 v37, v35, v10
v_mul_f32 v38, v36, v10
v_mul_f32 v39, v36, v11
v_fma_f32 v38, -v37, v11, v38
v_fmac_f32 v39, v37, v10
v_mul_f32 v40, v38, v10
v_mul_f32 v41, v38, v11
v_fma_f32 v40, -v39, v11, v40
v_fmac_f32 v41, v39, v10
v_cvt_pk_bf16_f32 v48, v32, v34
v_cvt_pk_bf16_f32 v49, v36, v36
v_cvt_pk_bf16_f32 v50, v36, v38
v_cvt_pk_bf16_f32 v51, v40, v40
v_cvt_pk_bf16_f32 v52, -v33, -v35
v_cvt_pk_bf16_f32 v53, -v37, -v37
v_cvt_pk_bf16_f32 v54, -v37, -v39
v_cvt_pk_bf16_f32 v55, -v41, -v41
v_xor_b32 v28, 16, v24
ds_write_b128 v28, v[48:51]
v_xor_b32 v29, 80, v24
ds_write_b128 v29, v[52:55]
v_mul_f32 v18, v16, v16
v_mul_f32 v19, v16, v17
v_fma_f32 v18, -v17, v17, v18
v_fmac_f32 v19, v17, v16
v_mul_f32 v32, v20, v18
v_mul_f32 v33, v20, v19
v_fma_f32 v32, -v21, v19, v32
v_fmac_f32 v33, v21, v18
v_mul_f32 v34, v32, v12
v_mul_f32 v35, v32, v13
v_fma_f32 v34, -v33, v13, v34
v_fmac_f32 v35, v33, v12
v_mul_f32 v36, v34, v12
v_mul_f32 v37, v34, v13
v_fma_f32 v36, -v35, v13, v36
v_fmac_f32 v37, v35, v12
v_mul_f32 v38, v32, v16
v_mul_f32 v39, v32, v17
v_fma_f32 v38, -v33, v17, v38
v_fmac_f32 v39, v33, v16
v_mul_f32 v40, v38, v12
v_mul_f32 v41, v38, v13
v_fma_f32 v40, -v39, v13, v40
v_fmac_f32 v41, v39, v12
v_mul_f32 v42, v40, v12
v_mul_f32 v43, v40, v13
v_fma_f32 v42, -v41, v13, v42
v_fmac_f32 v43, v41, v12
v_cvt_pk_bf16_f32 v48, v32, v34
v_cvt_pk_bf16_f32 v49, v36, v36
v_cvt_pk_bf16_f32 v50, v38, v40
v_cvt_pk_bf16_f32 v51, v42, v42
v_cvt_pk_bf16_f32 v52, -v33, -v35
v_cvt_pk_bf16_f32 v53, -v37, -v37
v_cvt_pk_bf16_f32 v54, -v39, -v41
v_cvt_pk_bf16_f32 v55, -v43, -v43
v_xor_b32 v28, 32, v24
ds_write_b128 v28, v[48:51]
v_xor_b32 v29, 96, v24
ds_write_b128 v29, v[52:55]
v_mul_f32 v22, v32, v18
v_mul_f32 v23, v32, v19
v_fma_f32 v22, -v33, v19, v22
v_fma_f32 v33, v33, v18, v23
v_mov_b32 v32, v22
v_mul_f32 v34, v32, v14
v_mul_f32 v35, v32, v15
v_fma_f32 v34, -v33, v15, v34
v_fmac_f32 v35, v33, v14
v_mul_f32 v36, v32, v16
v_mul_f32 v37, v32, v17
v_fma_f32 v36, -v33, v17, v36
v_fmac_f32 v37, v33, v16
v_mul_f32 v38, v36, v14
v_mul_f32 v39, v36, v15
v_fma_f32 v38, -v37, v15, v38
v_fmac_f32 v39, v37, v14
v_mul_f32 v40, v36, v16
v_mul_f32 v41, v36, v17
v_fma_f32 v40, -v37, v17, v40
v_fmac_f32 v41, v37, v16
v_mul_f32 v42, v40, v14
v_mul_f32 v43, v40, v15
v_fma_f32 v42, -v41, v15, v42
v_fmac_f32 v43, v41, v14
v_mul_f32 v44, v40, v16
v_mul_f32 v45, v40, v17
v_fma_f32 v44, -v41, v17, v44
v_fmac_f32 v45, v41, v16
v_mul_f32 v46, v44, v14
v_mul_f32 v47, v44, v15
v_fma_f32 v46, -v45, v15, v46
v_fmac_f32 v47, v45, v14
v_cvt_pk_bf16_f32 v48, v32, v34
v_cvt_pk_bf16_f32 v49, v36, v38
v_cvt_pk_bf16_f32 v50, v40, v42
v_cvt_pk_bf16_f32 v51, v44, v46
v_cvt_pk_bf16_f32 v52, -v33, -v35
v_cvt_pk_bf16_f32 v53, -v37, -v39
v_cvt_pk_bf16_f32 v54, -v41, -v43
v_cvt_pk_bf16_f32 v55, -v45, -v47
v_xor_b32 v28, 48, v24
ds_write_b128 v28, v[48:51]
v_xor_b32 v29, 112, v24
ds_write_b128 v29, v[52:55]
ds_read_b64_tr_b16 v[160:161], v25 offset:0
ds_read_b64_tr_b16 v[162:163], v26 offset:256
ds_read_b64_tr_b16 v[164:165], v25 offset:1024
ds_read_b64_tr_b16 v[166:167], v26 offset:1280
ds_read_b64_tr_b16 v[168:169], v25 offset:2048
ds_read_b64_tr_b16 v[170:171], v26 offset:2304
ds_read_b64_tr_b16 v[172:173], v25 offset:3072
ds_read_b64_tr_b16 v[174:175], v26 offset:3328
ds_read_b64_tr_b16 v[176:177], v25 offset:4096
ds_read_b64_tr_b16 v[178:179], v26 offset:4352
ds_read_b64_tr_b16 v[180:181], v25 offset:5120
ds_read_b64_tr_b16 v[182:183], v26 offset:5376
ds_read_b64_tr_b16 v[184:185], v25 offset:6144
ds_read_b64_tr_b16 v[186:187], v26 offset:6400
ds_read_b64_tr_b16 v[188:189], v25 offset:7168
ds_read_b64_tr_b16 v[190:191], v26 offset:7424
s_mul_i32 s27, s30, 12544
s_add_u32 s27, s27, s34
s_add_u32 s28, s34, s34
s_add_u32 s28, s28, 12544
s_sub_u32 s28, s28, s27
v_add_u32 v28, s27, v60
v_add_u32 v29, s28, v60
s_waitcnt lgkmcnt(14)
v_mfma_f32_32x32x16_bf16 v[192:207], v[160:163], v[128:131], 0
s_waitcnt lgkmcnt(12)
v_mfma_f32_32x32x16_bf16 v[192:207], v[164:167], v[132:135], v[192:207]
s_waitcnt lgkmcnt(10)
v_mfma_f32_32x32x16_bf16 v[192:207], v[168:171], v[136:139], v[192:207]
s_waitcnt lgkmcnt(8)
v_mfma_f32_32x32x16_bf16 v[192:207], v[172:175], v[140:143], v[192:207]
s_waitcnt lgkmcnt(6)
v_mfma_f32_32x32x16_bf16 v[192:207], v[176:179], v[144:147], v[192:207]
s_waitcnt lgkmcnt(4)
v_mfma_f32_32x32x16_bf16 v[192:207], v[180:183], v[148:151], v[192:207]
s_waitcnt lgkmcnt(2)
v_mfma_f32_32x32x16_bf16 v[192:207], v[184:187], v[152:155], v[192:207]
s_waitcnt lgkmcnt(0)
v_mfma_f32_32x32x16_bf16 v[192:207], v[188:191], v[156:159], v[192:207]
s_mul_i32 s27, s30, 4160
s_add_u32 s27, s27, s34
s_add_u32 s27, s27, 4080
v_and_b32 v8, 31, v0
v_lshlrev_b32 v8, 4, v8
v_sub_u32 v8, s27, v8
v_lshrrev_b32 v9, 5, v0
v_lshlrev_b32 v10, 3, v9
v_sub_u32 v30, v8, v10
v_lshlrev_b32 v10, 9, v9
v_sub_u32 v31, v8, v10
v_lshlrev_b32 v10, 10, v9
v_sub_u32 v7, v8, v10
v_add_u32 v11, s27, v60
v_mov_b32 v12, 0
v_mov_b32 v13, 0
v_mov_b32 v14, 0
v_mov_b32 v15, 0
ds_write_b128 v28, v[192:195] offset:0
ds_write_b128 v28, v[196:199] offset:1024
ds_write_b128 v28, v[200:203] offset:2048
ds_write_b128 v28, v[204:207] offset:3072
v_mov_b32 v58, 1
ds_write_b32 v56, v58 offset:512
ds_read_b32 v59, v57 offset:1024
AS_1:
s_waitcnt lgkmcnt(0)
v_cmp_gt_u32 vcc, 1, v59
s_cbranch_vccz AD_2
ds_read_b32 v59, v57 offset:1024
s_add_u32 s49, s49, 1
s_cmp_lt_u32 s49, 131072
s_cbranch_scc1 AS_1
AD_2:
ds_read_b128 v[208:211], v29 offset:0
ds_read_b128 v[212:215], v29 offset:1024
ds_read_b128 v[216:219], v29 offset:2048
ds_read_b128 v[220:223], v29 offset:3072
s_mov_b64 exec, 7
ds_write_b128 v11, v[12:15] offset:4096
s_mov_b64 exec, 1
v_mov_b32 v12, s21
s_mov_b64 exec, -1
s_waitcnt lgkmcnt(1)
s_mov_b32 vcc_lo, 0xaaaaaaaa
s_mov_b32 vcc_hi, 0xaaaaaaaa
v_add_f32 v192, v192, v12
v_pk_add_f32 v[192:193], v[192:193], v[208:209]
v_pk_add_f32 v[194:195], v[194:195], v[210:211]
v_pk_add_f32 v[196:197], v[196:197], v[212:213]
v_pk_add_f32 v[198:199], v[198:199], v[214:215]
v_pk_add_f32 v[200:201], v[200:201], v[216:217]
v_pk_add_f32 v[202:203], v[202:203], v[218:219]
v_pk_add_f32 v[204:205], v[204:205], v[220:221]
v_pk_add_f32 v[206:207], v[206:207], v[222:223]
s_cmp_eq_u32 s30, 0
s_cbranch_scc1 ATAP_3
v_cvt_pk_bf16_f32 v32, v195, v194
v_cvt_pk_bf16_f32 v33, v193, v192
ds_write_b64 v30, v[32:33] offset:4104
v_cvt_pk_bf16_f32 v34, v198, v197
v_cvt_pk_bf16_f32 v35, v196, v196
ds_write_b64 v30, v[34:35] offset:3592
v_cvt_pk_bf16_f32 v36, v202, v202
v_cvt_pk_bf16_f32 v37, v201, v201
v_cvt_pk_bf16_f32 v38, v201, v200
v_cvt_pk_bf16_f32 v39, v200, v200
ds_write_b128 v31, v[36:39] offset:3072
v_cndmask_b32 v8, v204, v205, vcc
v_cvt_pk_bf16_f32 v40, v205, v205
v_cvt_pk_bf16_f32 v41, v205, v8
v_cvt_pk_bf16_f32 v42, v204, v204
v_cvt_pk_bf16_f32 v43, v204, v204
ds_write_b128 v7, v[40:43] offset:2048
v_cndmask_b32 v8, v206, v207, vcc
v_cvt_pk_bf16_f32 v44, v207, v207
v_cvt_pk_bf16_f32 v45, v207, v8
v_cvt_pk_bf16_f32 v46, v206, v206
v_cvt_pk_bf16_f32 v47, v206, v206
ds_write_b128 v7, v[44:47] offset:1536
s_branch ATAP_4
ATAP_3:
v_cvt_pk_bf16_f32 v34, v197, v196
v_cvt_pk_bf16_f32 v35, v196, v196
ds_write_b64 v30, v[34:35] offset:3592
v_cvt_pk_bf16_f32 v32, v194, v193
v_cvt_pk_bf16_f32 v33, v192, v195
ds_write_b32 v30, v32 offset:4104
ds_write_b16 v30, v33 offset:4108
ds_write_b16_d16_hi v30, v33 offset:4102
v_cvt_pk_bf16_f32 v36, v202, v201
v_cvt_pk_bf16_f32 v37, v201, v201
v_cvt_pk_bf16_f32 v38, v200, v200
v_cvt_pk_bf16_f32 v39, v200, v200
ds_write_b128 v31, v[36:39] offset:3072
v_cndmask_b32 v8, v204, v205, vcc
v_cvt_pk_bf16_f32 v40, v205, v205
v_cvt_pk_bf16_f32 v41, v8, v204
v_cvt_pk_bf16_f32 v42, v204, v204
v_cvt_pk_bf16_f32 v43, v204, v204
ds_write_b128 v7, v[40:43] offset:2048
v_cndmask_b32 v8, v206, v207, vcc
v_cvt_pk_bf16_f32 v44, v207, v207
v_cvt_pk_bf16_f32 v45, v8, v206
v_cvt_pk_bf16_f32 v46, v206, v206
v_cvt_pk_bf16_f32 v47, v206, v206
ds_write_b128 v7, v[44:47] offset:1536
ATAP_4:
v_mov_b32 v58, 2
ds_write_b32 v56, v58 offset:512
v_lshrrev_b32 v94, 2, v6
s_lshl_b32 s28, s26, 11
s_add_u32 s28, s28, 155648
v_add_u32 v95, s28, v60
s_setprio 3
buffer_load_dword v92, v94, s[12:15], s56 offen offset:0 sc1
buffer_load_dwordx4 v[84:87], v6, s[12:15], s57 offen offset:0 sc1
buffer_load_dword v93, v94, s[12:15], s56 offen offset:256 sc1
buffer_load_dwordx4 v[88:91], v6, s[12:15], s57 offen offset:1024 sc1
s_setprio 0
ds_read_b32 v59, v57 offset:1024
v_and_b32 v12, 1, v0
v_mul_u32_u24 v13, 4162, v12
v_and_b32 v12, 15, v0
v_lshlrev_b32 v12, 1, v12
v_sub_u32 v13, v13, v12
v_lshrrev_b32 v12, 4, v0
v_lshl_add_u32 v13, v12, 4, v13
s_lshl_b32 s27, s30, 6
s_sub_u32 s27, s34, s27
s_add_u32 s27, s27, 7260
v_add_u32 v8, s27, v13
v_add_u32 v9, 0xfffffc00, v8
v_add_u32 v10, 0xfffff800, v8
v_add_u32 v11, 0xfffff400, v8
v_and_b32 v14, 15, v0
v_lshrrev_b32 v15, 4, v0
v_lshl_add_u32 v14, v14, 1, v15
s_lshl_b32 s27, s30, 2
s_sub_u32 s27, 6, s27
v_add_u32 v14, s27, v14
v_bfe_u32 v15, v14, 3, 1
v_xor_b32 v15, s33, v15
v_lshlrev_b32 v15, 4, v15
v_lshl_add_u32 v14, v14, 5, v15
v_add_u32 v12, 154624, v14
v_xor_b32 v14, 16, v14
v_add_u32 v13, 154624, v14
AS_5:
s_waitcnt lgkmcnt(0)
v_cmp_gt_u32 vcc, 2, v59
s_cbranch_vccz AD_6
ds_read_b32 v59, v57 offset:1024
s_add_u32 s49, s49, 1
s_cmp_lt_u32 s49, 131072
s_cbranch_scc1 AS_5
AD_6:
ds_read2_b32 v[140:141], v8 offset0:128 offset1:129
ds_read2_b32 v[142:143], v8 offset0:130 offset1:131
ds_read2_b32 v[156:157], v8 offset0:0 offset1:1
ds_read2_b32 v[158:159], v8 offset0:2 offset1:3
ds_read2_b32 v[172:173], v9 offset0:128 offset1:129
ds_read2_b32 v[174:175], v9 offset0:130 offset1:131
ds_read2_b32 v[188:189], v9 offset0:0 offset1:1
ds_read2_b32 v[190:191], v9 offset0:2 offset1:3
ds_read2_b32 v[204:205], v10 offset0:128 offset1:129
ds_read2_b32 v[206:207], v10 offset0:130 offset1:131
ds_read2_b32 v[220:221], v10 offset0:0 offset1:1
ds_read2_b32 v[222:223], v10 offset0:2 offset1:3
ds_read2_b32 v[236:237], v11 offset0:128 offset1:129
ds_read2_b32 v[238:239], v11 offset0:130 offset1:131
ds_read2_b32 v[252:253], v11 offset0:0 offset1:1
ds_read2_b32 v[254:255], v11 offset0:2 offset1:3
ds_read2_b32 v[136:137], v8 offset0:160 offset1:161
ds_read2_b32 v[138:139], v8 offset0:162 offset1:163
ds_read2_b32 v[152:153], v8 offset0:32 offset1:33
ds_read2_b32 v[154:155], v8 offset0:34 offset1:35
ds_read2_b32 v[168:169], v9 offset0:160 offset1:161
ds_read2_b32 v[170:171], v9 offset0:162 offset1:163
ds_read2_b32 v[184:185], v9 offset0:32 offset1:33
ds_read2_b32 v[186:187], v9 offset0:34 offset1:35
ds_read2_b32 v[200:201], v10 offset0:160 offset1:161
ds_read2_b32 v[202:203], v10 offset0:162 offset1:163
ds_read2_b32 v[216:217], v10 offset0:32 offset1:33
ds_read2_b32 v[218:219], v10 offset0:34 offset1:35
ds_read2_b32 v[232:233], v11 offset0:160 offset1:161
ds_read2_b32 v[234:235], v11 offset0:162 offset1:163
ds_read2_b32 v[248:249], v11 offset0:32 offset1:33
ds_read2_b32 v[250:251], v11 offset0:34 offset1:35
ds_read2_b32 v[132:133], v8 offset0:192 offset1:193
ds_read2_b32 v[134:135], v8 offset0:194 offset1:195
ds_read2_b32 v[148:149], v8 offset0:64 offset1:65
ds_read2_b32 v[150:151], v8 offset0:66 offset1:67
s_mov_b32 s51, 0
AUC_7:
s_waitcnt vmcnt(2)
v_add3_u32 v16, v84, v85, v86
v_add3_u32 v16, v16, v87, s48
v_cmp_ne_u32 vcc, v16, v92
s_cbranch_vccnz AUR_8
AUK_9:
ds_write_b128 v95, v[84:87] offset:0
AUC_10:
s_waitcnt vmcnt(0)
v_add3_u32 v16, v88, v89, v90
v_add3_u32 v16, v16, v91, s48
v_cmp_ne_u32 vcc, v16, v93
s_cbranch_vccnz AUR_11
AUK_12:
ds_write_b128 v95, v[88:91] offset:1024
ds_read2_b32 v[164:165], v9 offset0:192 offset1:193
ds_read2_b32 v[166:167], v9 offset0:194 offset1:195
ds_read2_b32 v[180:181], v9 offset0:64 offset1:65
ds_read2_b32 v[182:183], v9 offset0:66 offset1:67
ds_read2_b32 v[196:197], v10 offset0:192 offset1:193
ds_read2_b32 v[198:199], v10 offset0:194 offset1:195
ds_read2_b32 v[212:213], v10 offset0:64 offset1:65
ds_read2_b32 v[214:215], v10 offset0:66 offset1:67
ds_read2_b32 v[228:229], v11 offset0:192 offset1:193
ds_read2_b32 v[230:231], v11 offset0:194 offset1:195
ds_read2_b32 v[244:245], v11 offset0:64 offset1:65
ds_read2_b32 v[246:247], v11 offset0:66 offset1:67
ds_read2_b32 v[128:129], v8 offset0:224 offset1:225
ds_read2_b32 v[130:131], v8 offset0:226 offset1:227
ds_read2_b32 v[144:145], v8 offset0:96 offset1:97
ds_read2_b32 v[146:147], v8 offset0:98 offset1:99
ds_read2_b32 v[160:161], v9 offset0:224 offset1:225
ds_read2_b32 v[162:163], v9 offset0:226 offset1:227
ds_read2_b32 v[176:177], v9 offset0:96 offset1:97
ds_read2_b32 v[178:179], v9 offset0:98 offset1:99
ds_read2_b32 v[192:193], v10 offset0:224 offset1:225
ds_read2_b32 v[194:195], v10 offset0:226 offset1:227
ds_read2_b32 v[208:209], v10 offset0:96 offset1:97
ds_read2_b32 v[210:211], v10 offset0:98 offset1:99
ds_read2_b32 v[224:225], v11 offset0:224 offset1:225
ds_read2_b32 v[226:227], v11 offset0:226 offset1:227
ds_read2_b32 v[240:241], v11 offset0:96 offset1:97
ds_read2_b32 v[242:243], v11 offset0:98 offset1:99
v_and_b32 v16, 15, v0
v_lshrrev_b32 v17, 4, v0
v_lshlrev_b32 v18, 2, v17
v_xor_b32 v16, v16, v18
v_lshl_add_u32 v16, v17, 4, v16
v_lshlrev_b32 v16, 4, v16
s_lshl_b32 s27, s26, 13
s_add_u32 s27, s27, 121344
v_add_u32 v14, s27, v16
v_lshrrev_b32 v16, 2, v0
v_and_b32 v17, 3, v0
v_lshlrev_b32 v18, 2, v17
v_xor_b32 v16, v16, v18
v_lshl_add_u32 v16, v17, 4, v16
v_lshlrev_b32 v16, 4, v16
s_lshl_b32 s27, s26, 11
s_add_u32 s27, s27, 121344
v_add_u32 v15, s27, v16
s_waitcnt lgkmcnt(0)
v_mov_b32 v58, 3
ds_write_b32 v56, v58 offset:512
ds_read_b32 v59, v57 offset:1024
AS_13:
s_waitcnt lgkmcnt(0)
v_cmp_gt_u32 vcc, 3, v59
s_cbranch_vccz AD_14
ds_read_b32 v59, v57 offset:1024
s_add_u32 s49, s49, 1
s_cmp_lt_u32 s49, 131072
s_cbranch_scc1 AS_13
AD_14:
ds_read_b32 v59, v57
AW_15:
s_waitcnt lgkmcnt(0)
v_cmp_gt_u32 vcc, 7, v59
s_cbranch_vccz AX_16
s_sleep 1
ds_read_b32 v59, v57
s_add_u32 s49, s49, 1
s_cmp_lt_u32 s49, 131072
s_cbranch_scc1 AW_15
AX_16:
ds_read_b128 v[64:67], v12 offset:0
ds_read_b128 v[68:71], v13 offset:256
ds_read_b128 v[72:75], v12 offset:512
ds_read_b128 v[76:79], v13 offset:768
ds_read_b128 v[80:83], v12 offset:1024
s_waitcnt lgkmcnt(4)
v_mfma_f32_16x16x32_bf16 v[124:127], v[252:255], v[64:67], 0
v_mfma_f32_16x16x32_bf16 v[120:123], v[236:239], v[64:67], 0
v_mfma_f32_16x16x32_bf16 v[116:119], v[220:223], v[64:67], 0
v_mfma_f32_16x16x32_bf16 v[112:115], v[204:207], v[64:67], 0
v_mfma_f32_16x16x32_bf16 v[108:111], v[188:191], v[64:67], 0
v_mfma_f32_16x16x32_bf16 v[104:107], v[172:175], v[64:67], 0
v_mfma_f32_16x16x32_bf16 v[100:103], v[156:159], v[64:67], 0
v_mfma_f32_16x16x32_bf16 v[96:99], v[140:143], v[64:67], 0
ds_read_b128 v[84:87], v13 offset:1280
s_waitcnt lgkmcnt(4)
v_mfma_f32_16x16x32_bf16 v[124:127], v[248:251], v[68:71], v[124:127]
v_mfma_f32_16x16x32_bf16 v[120:123], v[232:235], v[68:71], v[120:123]
v_mfma_f32_16x16x32_bf16 v[116:119], v[216:219], v[68:71], v[116:119]
v_mfma_f32_16x16x32_bf16 v[112:115], v[200:203], v[68:71], v[112:115]
v_mfma_f32_16x16x32_bf16 v[108:111], v[184:187], v[68:71], v[108:111]
v_mfma_f32_16x16x32_bf16 v[104:107], v[168:171], v[68:71], v[104:107]
v_mfma_f32_16x16x32_bf16 v[100:103], v[152:155], v[68:71], v[100:103]
v_mfma_f32_16x16x32_bf16 v[96:99], v[136:139], v[68:71], v[96:99]
ds_read_b128 v[88:91], v12 offset:1536
s_waitcnt lgkmcnt(4)
v_mfma_f32_16x16x32_bf16 v[124:127], v[244:247], v[72:75], v[124:127]
v_mfma_f32_16x16x32_bf16 v[120:123], v[228:231], v[72:75], v[120:123]
v_mfma_f32_16x16x32_bf16 v[116:119], v[212:215], v[72:75], v[116:119]
v_mfma_f32_16x16x32_bf16 v[112:115], v[196:199], v[72:75], v[112:115]
v_mfma_f32_16x16x32_bf16 v[108:111], v[180:183], v[72:75], v[108:111]
v_mfma_f32_16x16x32_bf16 v[104:107], v[164:167], v[72:75], v[104:107]
v_mfma_f32_16x16x32_bf16 v[100:103], v[148:151], v[72:75], v[100:103]
v_mfma_f32_16x16x32_bf16 v[96:99], v[132:135], v[72:75], v[96:99]
ds_read_b128 v[92:95], v13 offset:1792
s_waitcnt lgkmcnt(4)
v_mfma_f32_16x16x32_bf16 v[124:127], v[240:243], v[76:79], v[124:127]
v_mfma_f32_16x16x32_bf16 v[120:123], v[224:227], v[76:79], v[120:123]
v_mfma_f32_16x16x32_bf16 v[116:119], v[208:211], v[76:79], v[116:119]
v_mfma_f32_16x16x32_bf16 v[112:115], v[192:195], v[76:79], v[112:115]
v_mfma_f32_16x16x32_bf16 v[108:111], v[176:179], v[76:79], v[108:111]
v_mfma_f32_16x16x32_bf16 v[104:107], v[160:163], v[76:79], v[104:107]
v_mfma_f32_16x16x32_bf16 v[100:103], v[144:147], v[76:79], v[100:103]
v_mfma_f32_16x16x32_bf16 v[96:99], v[128:131], v[76:79], v[96:99]
ds_read_b128 v[64:67], v12 offset:2048
s_waitcnt lgkmcnt(4)
v_mfma_f32_16x16x32_bf16 v[124:127], v[236:239], v[80:83], v[124:127]
v_mfma_f32_16x16x32_bf16 v[120:123], v[220:223], v[80:83], v[120:123]
v_mfma_f32_16x16x32_bf16 v[116:119], v[204:207], v[80:83], v[116:119]
v_mfma_f32_16x16x32_bf16 v[112:115], v[188:191], v[80:83], v[112:115]
v_mfma_f32_16x16x32_bf16 v[108:111], v[172:175], v[80:83], v[108:111]
v_mfma_f32_16x16x32_bf16 v[104:107], v[156:159], v[80:83], v[104:107]
v_mfma_f32_16x16x32_bf16 v[100:103], v[140:143], v[80:83], v[100:103]
ds_read_b128 v[68:71], v13 offset:2304
s_waitcnt lgkmcnt(4)
v_mfma_f32_16x16x32_bf16 v[124:127], v[232:235], v[84:87], v[124:127]
v_mfma_f32_16x16x32_bf16 v[120:123], v[216:219], v[84:87], v[120:123]
v_mfma_f32_16x16x32_bf16 v[116:119], v[200:203], v[84:87], v[116:119]
v_mfma_f32_16x16x32_bf16 v[112:115], v[184:187], v[84:87], v[112:115]
v_mfma_f32_16x16x32_bf16 v[108:111], v[168:171], v[84:87], v[108:111]
v_mfma_f32_16x16x32_bf16 v[104:107], v[152:155], v[84:87], v[104:107]
v_mfma_f32_16x16x32_bf16 v[100:103], v[136:139], v[84:87], v[100:103]
ds_read_b128 v[72:75], v12 offset:2560
s_waitcnt lgkmcnt(4)
v_mfma_f32_16x16x32_bf16 v[124:127], v[228:231], v[88:91], v[124:127]
v_mfma_f32_16x16x32_bf16 v[120:123], v[212:215], v[88:91], v[120:123]
v_mfma_f32_16x16x32_bf16 v[116:119], v[196:199], v[88:91], v[116:119]
v_mfma_f32_16x16x32_bf16 v[112:115], v[180:183], v[88:91], v[112:115]
v_mfma_f32_16x16x32_bf16 v[108:111], v[164:167], v[88:91], v[108:111]
v_mfma_f32_16x16x32_bf16 v[104:107], v[148:151], v[88:91], v[104:107]
v_mfma_f32_16x16x32_bf16 v[100:103], v[132:135], v[88:91], v[100:103]
ds_read_b128 v[76:79], v13 offset:2816
s_waitcnt lgkmcnt(4)
v_mfma_f32_16x16x32_bf16 v[124:127], v[224:227], v[92:95], v[124:127]
v_mfma_f32_16x16x32_bf16 v[120:123], v[208:211], v[92:95], v[120:123]
v_mfma_f32_16x16x32_bf16 v[116:119], v[192:195], v[92:95], v[116:119]
v_mfma_f32_16x16x32_bf16 v[112:115], v[176:179], v[92:95], v[112:115]
v_mfma_f32_16x16x32_bf16 v[108:111], v[160:163], v[92:95], v[108:111]
v_mfma_f32_16x16x32_bf16 v[104:107], v[144:147], v[92:95], v[104:107]
v_mfma_f32_16x16x32_bf16 v[100:103], v[128:131], v[92:95], v[100:103]
ds_write_b128 v14, v[96:99] offset:0
ds_read_b128 v[80:83], v12 offset:3072
s_waitcnt lgkmcnt(4)
v_mfma_f32_16x16x32_bf16 v[124:127], v[220:223], v[64:67], v[124:127]
v_mfma_f32_16x16x32_bf16 v[120:123], v[204:207], v[64:67], v[120:123]
v_mfma_f32_16x16x32_bf16 v[116:119], v[188:191], v[64:67], v[116:119]
v_mfma_f32_16x16x32_bf16 v[112:115], v[172:175], v[64:67], v[112:115]
v_mfma_f32_16x16x32_bf16 v[108:111], v[156:159], v[64:67], v[108:111]
v_mfma_f32_16x16x32_bf16 v[104:107], v[140:143], v[64:67], v[104:107]
ds_read_b128 v[84:87], v13 offset:3328
s_waitcnt lgkmcnt(4)
v_mfma_f32_16x16x32_bf16 v[124:127], v[216:219], v[68:71], v[124:127]
v_mfma_f32_16x16x32_bf16 v[120:123], v[200:203], v[68:71], v[120:123]
v_mfma_f32_16x16x32_bf16 v[116:119], v[184:187], v[68:71], v[116:119]
v_mfma_f32_16x16x32_bf16 v[112:115], v[168:171], v[68:71], v[112:115]
v_mfma_f32_16x16x32_bf16 v[108:111], v[152:155], v[68:71], v[108:111]
v_mfma_f32_16x16x32_bf16 v[104:107], v[136:139], v[68:71], v[104:107]
ds_read_b128 v[88:91], v12 offset:3584
s_waitcnt lgkmcnt(4)
v_mfma_f32_16x16x32_bf16 v[124:127], v[212:215], v[72:75], v[124:127]
v_mfma_f32_16x16x32_bf16 v[120:123], v[196:199], v[72:75], v[120:123]
v_mfma_f32_16x16x32_bf16 v[116:119], v[180:183], v[72:75], v[116:119]
v_mfma_f32_16x16x32_bf16 v[112:115], v[164:167], v[72:75], v[112:115]
v_mfma_f32_16x16x32_bf16 v[108:111], v[148:151], v[72:75], v[108:111]
v_mfma_f32_16x16x32_bf16 v[104:107], v[132:135], v[72:75], v[104:107]
ds_read_b128 v[92:95], v13 offset:3840
s_waitcnt lgkmcnt(4)
v_mfma_f32_16x16x32_bf16 v[124:127], v[208:211], v[76:79], v[124:127]
v_mfma_f32_16x16x32_bf16 v[120:123], v[192:195], v[76:79], v[120:123]
v_mfma_f32_16x16x32_bf16 v[116:119], v[176:179], v[76:79], v[116:119]
v_mfma_f32_16x16x32_bf16 v[112:115], v[160:163], v[76:79], v[112:115]
v_mfma_f32_16x16x32_bf16 v[108:111], v[144:147], v[76:79], v[108:111]
v_mfma_f32_16x16x32_bf16 v[104:107], v[128:131], v[76:79], v[104:107]
ds_write_b128 v14, v[100:103] offset:1024
ds_read_b128 v[64:67], v12 offset:4096
s_waitcnt lgkmcnt(4)
v_mfma_f32_16x16x32_bf16 v[124:127], v[204:207], v[80:83], v[124:127]
v_mfma_f32_16x16x32_bf16 v[120:123], v[188:191], v[80:83], v[120:123]
v_mfma_f32_16x16x32_bf16 v[116:119], v[172:175], v[80:83], v[116:119]
v_mfma_f32_16x16x32_bf16 v[112:115], v[156:159], v[80:83], v[112:115]
v_mfma_f32_16x16x32_bf16 v[108:111], v[140:143], v[80:83], v[108:111]
ds_read_b128 v[68:71], v13 offset:4352
s_waitcnt lgkmcnt(4)
v_mfma_f32_16x16x32_bf16 v[124:127], v[200:203], v[84:87], v[124:127]
v_mfma_f32_16x16x32_bf16 v[120:123], v[184:187], v[84:87], v[120:123]
v_mfma_f32_16x16x32_bf16 v[116:119], v[168:171], v[84:87], v[116:119]
v_mfma_f32_16x16x32_bf16 v[112:115], v[152:155], v[84:87], v[112:115]
v_mfma_f32_16x16x32_bf16 v[108:111], v[136:139], v[84:87], v[108:111]
ds_read_b128 v[72:75], v12 offset:4608
s_waitcnt lgkmcnt(4)
v_mfma_f32_16x16x32_bf16 v[124:127], v[196:199], v[88:91], v[124:127]
v_mfma_f32_16x16x32_bf16 v[120:123], v[180:183], v[88:91], v[120:123]
v_mfma_f32_16x16x32_bf16 v[116:119], v[164:167], v[88:91], v[116:119]
v_mfma_f32_16x16x32_bf16 v[112:115], v[148:151], v[88:91], v[112:115]
v_mfma_f32_16x16x32_bf16 v[108:111], v[132:135], v[88:91], v[108:111]
ds_read_b128 v[76:79], v13 offset:4864
s_waitcnt lgkmcnt(4)
v_mfma_f32_16x16x32_bf16 v[124:127], v[192:195], v[92:95], v[124:127]
v_mfma_f32_16x16x32_bf16 v[120:123], v[176:179], v[92:95], v[120:123]
v_mfma_f32_16x16x32_bf16 v[116:119], v[160:163], v[92:95], v[116:119]
v_mfma_f32_16x16x32_bf16 v[112:115], v[144:147], v[92:95], v[112:115]
v_mfma_f32_16x16x32_bf16 v[108:111], v[128:131], v[92:95], v[108:111]
ds_write_b128 v14, v[104:107] offset:2048
ds_read_b128 v[80:83], v12 offset:5120
s_waitcnt lgkmcnt(4)
v_mfma_f32_16x16x32_bf16 v[124:127], v[188:191], v[64:67], v[124:127]
v_mfma_f32_16x16x32_bf16 v[120:123], v[172:175], v[64:67], v[120:123]
v_mfma_f32_16x16x32_bf16 v[116:119], v[156:159], v[64:67], v[116:119]
v_mfma_f32_16x16x32_bf16 v[112:115], v[140:143], v[64:67], v[112:115]
ds_read_b128 v[84:87], v13 offset:5376
s_waitcnt lgkmcnt(4)
v_mfma_f32_16x16x32_bf16 v[124:127], v[184:187], v[68:71], v[124:127]
v_mfma_f32_16x16x32_bf16 v[120:123], v[168:171], v[68:71], v[120:123]
v_mfma_f32_16x16x32_bf16 v[116:119], v[152:155], v[68:71], v[116:119]
v_mfma_f32_16x16x32_bf16 v[112:115], v[136:139], v[68:71], v[112:115]
ds_read_b128 v[88:91], v12 offset:5632
s_waitcnt lgkmcnt(4)
v_mfma_f32_16x16x32_bf16 v[124:127], v[180:183], v[72:75], v[124:127]
v_mfma_f32_16x16x32_bf16 v[120:123], v[164:167], v[72:75], v[120:123]
v_mfma_f32_16x16x32_bf16 v[116:119], v[148:151], v[72:75], v[116:119]
v_mfma_f32_16x16x32_bf16 v[112:115], v[132:135], v[72:75], v[112:115]
ds_read_b128 v[92:95], v13 offset:5888
s_waitcnt lgkmcnt(4)
v_mfma_f32_16x16x32_bf16 v[124:127], v[176:179], v[76:79], v[124:127]
v_mfma_f32_16x16x32_bf16 v[120:123], v[160:163], v[76:79], v[120:123]
v_mfma_f32_16x16x32_bf16 v[116:119], v[144:147], v[76:79], v[116:119]
v_mfma_f32_16x16x32_bf16 v[112:115], v[128:131], v[76:79], v[112:115]
ds_write_b128 v14, v[108:111] offset:3072
ds_read_b128 v[64:67], v12 offset:6144
s_waitcnt lgkmcnt(4)
v_mfma_f32_16x16x32_bf16 v[124:127], v[172:175], v[80:83], v[124:127]
v_mfma_f32_16x16x32_bf16 v[120:123], v[156:159], v[80:83], v[120:123]
v_mfma_f32_16x16x32_bf16 v[116:119], v[140:143], v[80:83], v[116:119]
ds_read_b128 v[68:71], v13 offset:6400
s_waitcnt lgkmcnt(4)
v_mfma_f32_16x16x32_bf16 v[124:127], v[168:171], v[84:87], v[124:127]
v_mfma_f32_16x16x32_bf16 v[120:123], v[152:155], v[84:87], v[120:123]
v_mfma_f32_16x16x32_bf16 v[116:119], v[136:139], v[84:87], v[116:119]
ds_read_b128 v[72:75], v12 offset:6656
s_waitcnt lgkmcnt(4)
v_mfma_f32_16x16x32_bf16 v[124:127], v[164:167], v[88:91], v[124:127]
v_mfma_f32_16x16x32_bf16 v[120:123], v[148:151], v[88:91], v[120:123]
v_mfma_f32_16x16x32_bf16 v[116:119], v[132:135], v[88:91], v[116:119]
ds_read_b128 v[76:79], v13 offset:6912
s_waitcnt lgkmcnt(4)
v_mfma_f32_16x16x32_bf16 v[124:127], v[160:163], v[92:95], v[124:127]
v_mfma_f32_16x16x32_bf16 v[120:123], v[144:147], v[92:95], v[120:123]
v_mfma_f32_16x16x32_bf16 v[116:119], v[128:131], v[92:95], v[116:119]
ds_write_b128 v14, v[112:115] offset:4096
ds_read_b128 v[80:83], v12 offset:7168
s_waitcnt lgkmcnt(4)
v_mfma_f32_16x16x32_bf16 v[124:127], v[156:159], v[64:67], v[124:127]
v_mfma_f32_16x16x32_bf16 v[120:123], v[140:143], v[64:67], v[120:123]
ds_read_b128 v[84:87], v13 offset:7424
s_waitcnt lgkmcnt(4)
v_mfma_f32_16x16x32_bf16 v[124:127], v[152:155], v[68:71], v[124:127]
v_mfma_f32_16x16x32_bf16 v[120:123], v[136:139], v[68:71], v[120:123]
ds_read_b128 v[88:91], v12 offset:7680
s_waitcnt lgkmcnt(4)
v_mfma_f32_16x16x32_bf16 v[124:127], v[148:151], v[72:75], v[124:127]
v_mfma_f32_16x16x32_bf16 v[120:123], v[132:135], v[72:75], v[120:123]
ds_read_b128 v[92:95], v13 offset:7936
s_waitcnt lgkmcnt(4)
v_mfma_f32_16x16x32_bf16 v[124:127], v[144:147], v[76:79], v[124:127]
v_mfma_f32_16x16x32_bf16 v[120:123], v[128:131], v[76:79], v[120:123]
ds_write_b128 v14, v[116:119] offset:5120
s_waitcnt lgkmcnt(3)
v_mfma_f32_16x16x32_bf16 v[124:127], v[140:143], v[80:83], v[124:127]
s_waitcnt lgkmcnt(2)
v_mfma_f32_16x16x32_bf16 v[124:127], v[136:139], v[84:87], v[124:127]
s_waitcnt lgkmcnt(1)
v_mfma_f32_16x16x32_bf16 v[124:127], v[132:135], v[88:91], v[124:127]
s_waitcnt lgkmcnt(0)
v_mfma_f32_16x16x32_bf16 v[124:127], v[128:131], v[92:95], v[124:127]
ds_write_b128 v14, v[120:123] offset:6144
s_nop 6
ds_write_b128 v14, v[124:127] offset:7168
v_mov_b32 v58, 4
ds_write_b32 v56, v58 offset:512
ds_read_b32 v59, v57 offset:1024
AS_17:
s_waitcnt lgkmcnt(0)
v_cmp_gt_u32 vcc, 4, v59
s_cbranch_vccz AD_18
ds_read_b32 v59, v57 offset:1024
s_add_u32 s49, s49, 1
s_cmp_lt_u32 s49, 131072
s_cbranch_scc1 AS_17
AD_18:
ds_read_b128 v[128:131], v15 offset:0
ds_read_b128 v[132:135], v15 offset:8192
ds_read_b128 v[136:139], v15 offset:16384
ds_read_b128 v[140:143], v15 offset:24576
ds_read_b128 v[144:147], v15 offset:1024
ds_read_b128 v[148:151], v15 offset:9216
ds_read_b128 v[152:155], v15 offset:17408
ds_read_b128 v[156:159], v15 offset:25600
v_lshlrev_b32 v16, 2, v0
s_setprio 0
s_waitcnt lgkmcnt(4)
v_pk_add_f32 v[128:129], v[128:129], v[132:133]
v_pk_add_f32 v[136:137], v[136:137], v[140:141]
v_pk_add_f32 v[130:131], v[130:131], v[134:135]
v_pk_add_f32 v[138:139], v[138:139], v[142:143]
v_cvt_pk_bf16_f32 v132, v128, v136
v_cvt_pk_bf16_f32 v133, v129, v137
v_cvt_pk_bf16_f32 v134, v130, v138
v_cvt_pk_bf16_f32 v135, v131, v139
v_add3_u32 v128, v132, v133, v134
v_add3_u32 v128, v128, v135, s48
buffer_store_dwordx4 v[132:135], v60, s[12:15], s55 offen offset:0 sc1
buffer_store_dword v128, v16, s[12:15], s54 offen offset:0 sc1
s_waitcnt lgkmcnt(0)
v_pk_add_f32 v[144:145], v[144:145], v[148:149]
v_pk_add_f32 v[152:153], v[152:153], v[156:157]
v_pk_add_f32 v[146:147], v[146:147], v[150:151]
v_pk_add_f32 v[154:155], v[154:155], v[158:159]
v_cvt_pk_bf16_f32 v148, v144, v152
v_cvt_pk_bf16_f32 v149, v145, v153
v_cvt_pk_bf16_f32 v150, v146, v154
v_cvt_pk_bf16_f32 v151, v147, v155
v_add3_u32 v144, v148, v149, v150
v_add3_u32 v144, v144, v151, s48
buffer_store_dwordx4 v[148:151], v60, s[12:15], s55 offen offset:1024 sc1
buffer_store_dword v144, v16, s[12:15], s54 offen offset:256 sc1
K_END:
s_endpgm
BTR_18:
s_add_u32 s51, s51, 1
s_cmp_ge_u32 s51, 4096
s_cbranch_scc1 BTK_19
s_sleep 3
buffer_load_dwordx4 v[68:71], v79, s[12:15], s3 offen offset:0 sc1
buffer_load_dwordx4 v[72:75], v79, s[12:15], s3 offen offset:16 sc1
s_waitcnt vmcnt(0)
s_branch BTC_17
BGR_21:
s_add_u32 s51, s51, 1
s_cmp_ge_u32 s51, 4096
s_cbranch_scc1 BGK_22
s_sleep 3
buffer_load_dword v128, v15, s[12:15], s55 offen offset:0 sc1
buffer_load_dwordx4 v[28:31], v17, s[12:15], s52 offen offset:0 sc1
buffer_load_dword v129, v15, s[12:15], s55 offen offset:256 sc1
buffer_load_dwordx4 v[32:35], v17, s[12:15], s52 offen offset:1024 sc1
buffer_load_dword v130, v15, s[12:15], s55 offen offset:512 sc1
buffer_load_dwordx4 v[36:39], v17, s[12:15], s52 offen offset:2048 sc1
buffer_load_dword v131, v15, s[12:15], s55 offen offset:768 sc1
buffer_load_dwordx4 v[40:43], v17, s[12:15], s52 offen offset:3072 sc1
buffer_load_dword v132, v15, s[12:15], s55 offen offset:1024 sc1
buffer_load_dwordx4 v[44:47], v17, s[12:15], s53 offen offset:0 sc1
buffer_load_dword v133, v15, s[12:15], s55 offen offset:1280 sc1
buffer_load_dwordx4 v[48:51], v17, s[12:15], s53 offen offset:1024 sc1
buffer_load_dword v134, v15, s[12:15], s55 offen offset:1536 sc1
buffer_load_dwordx4 v[52:55], v17, s[12:15], s53 offen offset:2048 sc1
buffer_load_dword v135, v15, s[12:15], s55 offen offset:1792 sc1
buffer_load_dwordx4 v[56:59], v17, s[12:15], s53 offen offset:3072 sc1
buffer_load_dword v136, v16, s[12:15], s38 offen sc1
buffer_load_dwordx4 v[60:63], v14, s[12:15], s54 offen sc1
s_branch BGC_20
BHR_25:
s_add_u32 s51, s51, 1
s_cmp_ge_u32 s51, 4096
s_cbranch_scc1 BHK_26
s_sleep 3
buffer_load_dword v118, v15, s[12:15], s61 offen offset:0 sc1
buffer_load_dwordx4 v[20:23], v17, s[12:15], s56 offen offset:0 sc1
buffer_load_dwordx4 v[24:27], v17, s[12:15], s56 offen offset:1024 sc1
buffer_load_dword v119, v15, s[12:15], s61 offen offset:512 sc1
buffer_load_dwordx4 v[28:31], v17, s[12:15], s56 offen offset:2048 sc1
buffer_load_dwordx4 v[32:35], v17, s[12:15], s56 offen offset:3072 sc1
buffer_load_dword v120, v15, s[12:15], s61 offen offset:1024 sc1
buffer_load_dwordx4 v[36:39], v17, s[12:15], s57 offen offset:0 sc1
buffer_load_dwordx4 v[40:43], v17, s[12:15], s57 offen offset:1024 sc1
buffer_load_dword v121, v15, s[12:15], s61 offen offset:1536 sc1
buffer_load_dwordx4 v[44:47], v17, s[12:15], s57 offen offset:2048 sc1
buffer_load_dwordx4 v[48:51], v17, s[12:15], s57 offen offset:3072 sc1
s_waitcnt vmcnt(9)
v_add3_u32 v10, v20, v21, v22
v_add3_u32 v10, v10, v23, v24
v_add3_u32 v10, v10, v25, v26
v_add3_u32 v10, v10, v27, s48
v_cmp_ne_u32 vcc, v10, v118
s_cbranch_vccnz BHR_25
s_branch BHK_26
BHR_27:
s_add_u32 s51, s51, 1
s_cmp_ge_u32 s51, 4096
s_cbranch_scc1 BHK_28
s_sleep 3
buffer_load_dword v119, v15, s[12:15], s61 offen offset:512 sc1
buffer_load_dwordx4 v[28:31], v17, s[12:15], s56 offen offset:2048 sc1
buffer_load_dwordx4 v[32:35], v17, s[12:15], s56 offen offset:3072 sc1
buffer_load_dword v120, v15, s[12:15], s61 offen offset:1024 sc1
buffer_load_dwordx4 v[36:39], v17, s[12:15], s57 offen offset:0 sc1
buffer_load_dwordx4 v[40:43], v17, s[12:15], s57 offen offset:1024 sc1
buffer_load_dword v121, v15, s[12:15], s61 offen offset:1536 sc1
buffer_load_dwordx4 v[44:47], v17, s[12:15], s57 offen offset:2048 sc1
buffer_load_dwordx4 v[48:51], v17, s[12:15], s57 offen offset:3072 sc1
buffer_load_dword v122, v15, s[12:15], s61 offen offset:2048 sc1
buffer_load_dwordx4 v[52:55], v17, s[12:15], s58 offen offset:0 sc1
buffer_load_dwordx4 v[56:59], v17, s[12:15], s58 offen offset:1024 sc1
buffer_load_dword v123, v15, s[12:15], s61 offen offset:2560 sc1
buffer_load_dwordx4 v[60:63], v17, s[12:15], s58 offen offset:2048 sc1
buffer_load_dwordx4 v[64:67], v17, s[12:15], s58 offen offset:3072 sc1
buffer_load_dword v124, v15, s[12:15], s61 offen offset:3072 sc1
buffer_load_dwordx4 v[68:71], v17, s[12:15], s59 offen offset:0 sc1
s_waitcnt vmcnt(14)
v_add3_u32 v10, v28, v29, v30
v_add3_u32 v10, v10, v31, v32
v_add3_u32 v10, v10, v33, v34
v_add3_u32 v10, v10, v35, s48
v_cmp_ne_u32 vcc, v10, v119
s_cbranch_vccnz BHR_27
s_branch BHK_28
BHR_29:
s_add_u32 s51, s51, 1
s_cmp_ge_u32 s51, 4096
s_cbranch_scc1 BHK_30
s_sleep 3
buffer_load_dword v120, v15, s[12:15], s61 offen offset:1024 sc1
buffer_load_dwordx4 v[36:39], v17, s[12:15], s57 offen offset:0 sc1
buffer_load_dwordx4 v[40:43], v17, s[12:15], s57 offen offset:1024 sc1
buffer_load_dword v121, v15, s[12:15], s61 offen offset:1536 sc1
buffer_load_dwordx4 v[44:47], v17, s[12:15], s57 offen offset:2048 sc1
buffer_load_dwordx4 v[48:51], v17, s[12:15], s57 offen offset:3072 sc1
buffer_load_dword v122, v15, s[12:15], s61 offen offset:2048 sc1
buffer_load_dwordx4 v[52:55], v17, s[12:15], s58 offen offset:0 sc1
buffer_load_dwordx4 v[56:59], v17, s[12:15], s58 offen offset:1024 sc1
buffer_load_dword v123, v15, s[12:15], s61 offen offset:2560 sc1
buffer_load_dwordx4 v[60:63], v17, s[12:15], s58 offen offset:2048 sc1
buffer_load_dwordx4 v[64:67], v17, s[12:15], s58 offen offset:3072 sc1
buffer_load_dword v124, v15, s[12:15], s61 offen offset:3072 sc1
buffer_load_dwordx4 v[68:71], v17, s[12:15], s59 offen offset:0 sc1
buffer_load_dwordx4 v[72:75], v17, s[12:15], s59 offen offset:1024 sc1
buffer_load_dword v125, v15, s[12:15], s61 offen offset:3584 sc1
buffer_load_dwordx4 v[76:79], v17, s[12:15], s59 offen offset:2048 sc1
buffer_load_dwordx4 v[80:83], v17, s[12:15], s59 offen offset:3072 sc1
s_waitcnt vmcnt(15)
v_add3_u32 v10, v36, v37, v38
v_add3_u32 v10, v10, v39, v40
v_add3_u32 v10, v10, v41, v42
v_add3_u32 v10, v10, v43, s48
v_cmp_ne_u32 vcc, v10, v120
s_cbranch_vccnz BHR_29
s_branch BHK_30
BHR_31:
s_add_u32 s51, s51, 1
s_cmp_ge_u32 s51, 4096
s_cbranch_scc1 BHK_32
s_sleep 3
buffer_load_dword v121, v15, s[12:15], s61 offen offset:1536 sc1
buffer_load_dwordx4 v[44:47], v17, s[12:15], s57 offen offset:2048 sc1
buffer_load_dwordx4 v[48:51], v17, s[12:15], s57 offen offset:3072 sc1
buffer_load_dword v122, v15, s[12:15], s61 offen offset:2048 sc1
buffer_load_dwordx4 v[52:55], v17, s[12:15], s58 offen offset:0 sc1
buffer_load_dwordx4 v[56:59], v17, s[12:15], s58 offen offset:1024 sc1
buffer_load_dword v123, v15, s[12:15], s61 offen offset:2560 sc1
buffer_load_dwordx4 v[60:63], v17, s[12:15], s58 offen offset:2048 sc1
buffer_load_dwordx4 v[64:67], v17, s[12:15], s58 offen offset:3072 sc1
buffer_load_dword v124, v15, s[12:15], s61 offen offset:3072 sc1
buffer_load_dwordx4 v[68:71], v17, s[12:15], s59 offen offset:0 sc1
buffer_load_dwordx4 v[72:75], v17, s[12:15], s59 offen offset:1024 sc1
buffer_load_dword v125, v15, s[12:15], s61 offen offset:3584 sc1
buffer_load_dwordx4 v[76:79], v17, s[12:15], s59 offen offset:2048 sc1
buffer_load_dwordx4 v[80:83], v17, s[12:15], s59 offen offset:3072 sc1
s_waitcnt vmcnt(12)
v_add3_u32 v10, v44, v45, v46
v_add3_u32 v10, v10, v47, v48
v_add3_u32 v10, v10, v49, v50
v_add3_u32 v10, v10, v51, s48
v_cmp_ne_u32 vcc, v10, v121
s_cbranch_vccnz BHR_31
s_branch BHK_32
BHR_33:
s_add_u32 s51, s51, 1
s_cmp_ge_u32 s51, 4096
s_cbranch_scc1 BHK_34
s_sleep 3
buffer_load_dword v122, v15, s[12:15], s61 offen offset:2048 sc1
buffer_load_dwordx4 v[52:55], v17, s[12:15], s58 offen offset:0 sc1
buffer_load_dwordx4 v[56:59], v17, s[12:15], s58 offen offset:1024 sc1
buffer_load_dword v123, v15, s[12:15], s61 offen offset:2560 sc1
buffer_load_dwordx4 v[60:63], v17, s[12:15], s58 offen offset:2048 sc1
buffer_load_dwordx4 v[64:67], v17, s[12:15], s58 offen offset:3072 sc1
buffer_load_dword v124, v15, s[12:15], s61 offen offset:3072 sc1
buffer_load_dwordx4 v[68:71], v17, s[12:15], s59 offen offset:0 sc1
buffer_load_dwordx4 v[72:75], v17, s[12:15], s59 offen offset:1024 sc1
buffer_load_dword v125, v15, s[12:15], s61 offen offset:3584 sc1
buffer_load_dwordx4 v[76:79], v17, s[12:15], s59 offen offset:2048 sc1
buffer_load_dwordx4 v[80:83], v17, s[12:15], s59 offen offset:3072 sc1
s_waitcnt vmcnt(9)
v_add3_u32 v10, v52, v53, v54
v_add3_u32 v10, v10, v55, v56
v_add3_u32 v10, v10, v57, v58
v_add3_u32 v10, v10, v59, s48
v_cmp_ne_u32 vcc, v10, v122
s_cbranch_vccnz BHR_33
s_branch BHK_34
BHR_35:
s_add_u32 s51, s51, 1
s_cmp_ge_u32 s51, 4096
s_cbranch_scc1 BHK_36
s_sleep 3
buffer_load_dword v123, v15, s[12:15], s61 offen offset:2560 sc1
buffer_load_dwordx4 v[60:63], v17, s[12:15], s58 offen offset:2048 sc1
buffer_load_dwordx4 v[64:67], v17, s[12:15], s58 offen offset:3072 sc1
buffer_load_dword v124, v15, s[12:15], s61 offen offset:3072 sc1
buffer_load_dwordx4 v[68:71], v17, s[12:15], s59 offen offset:0 sc1
buffer_load_dwordx4 v[72:75], v17, s[12:15], s59 offen offset:1024 sc1
buffer_load_dword v125, v15, s[12:15], s61 offen offset:3584 sc1
buffer_load_dwordx4 v[76:79], v17, s[12:15], s59 offen offset:2048 sc1
buffer_load_dwordx4 v[80:83], v17, s[12:15], s59 offen offset:3072 sc1
s_waitcnt vmcnt(0)
s_waitcnt vmcnt(6)
v_add3_u32 v10, v60, v61, v62
v_add3_u32 v10, v10, v63, v64
v_add3_u32 v10, v10, v65, v66
v_add3_u32 v10, v10, v67, s48
v_cmp_ne_u32 vcc, v10, v123
s_cbranch_vccnz BHR_35
s_branch BHK_36
BHR_37:
s_add_u32 s51, s51, 1
s_cmp_ge_u32 s51, 4096
s_cbranch_scc1 BHK_38
s_sleep 3
buffer_load_dword v124, v15, s[12:15], s61 offen offset:3072 sc1
buffer_load_dwordx4 v[68:71], v17, s[12:15], s59 offen offset:0 sc1
buffer_load_dwordx4 v[72:75], v17, s[12:15], s59 offen offset:1024 sc1
buffer_load_dword v125, v15, s[12:15], s61 offen offset:3584 sc1
buffer_load_dwordx4 v[76:79], v17, s[12:15], s59 offen offset:2048 sc1
buffer_load_dwordx4 v[80:83], v17, s[12:15], s59 offen offset:3072 sc1
s_waitcnt vmcnt(0)
s_waitcnt vmcnt(3)
v_add3_u32 v10, v68, v69, v70
v_add3_u32 v10, v10, v71, v72
v_add3_u32 v10, v10, v73, v74
v_add3_u32 v10, v10, v75, s48
v_cmp_ne_u32 vcc, v10, v124
s_cbranch_vccnz BHR_37
s_branch BHK_38
BHR_39:
s_add_u32 s51, s51, 1
s_cmp_ge_u32 s51, 4096
s_cbranch_scc1 BHK_40
s_sleep 3
buffer_load_dword v125, v15, s[12:15], s61 offen offset:3584 sc1
buffer_load_dwordx4 v[76:79], v17, s[12:15], s59 offen offset:2048 sc1
buffer_load_dwordx4 v[80:83], v17, s[12:15], s59 offen offset:3072 sc1
s_waitcnt vmcnt(0)
s_waitcnt vmcnt(0)
v_add3_u32 v10, v76, v77, v78
v_add3_u32 v10, v10, v79, v80
v_add3_u32 v10, v10, v81, v82
v_add3_u32 v10, v10, v83, s48
v_cmp_ne_u32 vcc, v10, v125
s_cbranch_vccnz BHR_39
s_branch BHK_40
BAR_41:
s_add_u32 s51, s51, 1
s_cmp_ge_u32 s51, 4096
s_cbranch_scc1 BAK_42
s_sleep 3
buffer_load_dword v28, v5, s[12:15], s52 offen sc1
buffer_load_dword v29, v5, s[12:15], s53 offen sc1
buffer_load_dword v20, v4, s[12:15], s16 offen sc1
buffer_load_dword v21, v4, s[12:15], s17 offen sc1
buffer_load_dword v22, v4, s[12:15], s18 offen sc1
buffer_load_dword v23, v4, s[12:15], s19 offen sc1
buffer_load_dword v24, v4, s[12:15], s20 offen sc1
buffer_load_dword v25, v4, s[12:15], s21 offen sc1
buffer_load_dword v26, v4, s[12:15], s22 offen sc1
buffer_load_dword v27, v4, s[12:15], s23 offen sc1
s_waitcnt vmcnt(0)
v_add3_u32 v10, v20, v21, v22
v_add3_u32 v11, v28, v29, s63
v_add3_u32 v10, v10, v23, v24
v_sub_u32 v11, v27, v11
v_add3_u32 v10, v10, v25, v26
v_add_u32 v10, v10, v11
s_nop 1
v_add_u32_dpp v10, v10, v10 quad_perm:[1,0,3,2] row_mask:0xf bank_mask:0xf
s_nop 1
v_add_u32_dpp v10, v10, v10 quad_perm:[2,3,0,1] row_mask:0xf bank_mask:0xf
v_cmp_ne_u32 vcc, 0, v10
v_lshlrev_b32 v52, 16, v20
v_and_b32 v53, 0xffff0000, v20
v_lshlrev_b32 v54, 16, v21
v_and_b32 v55, 0xffff0000, v21
v_lshlrev_b32 v56, 16, v22
v_and_b32 v57, 0xffff0000, v22
v_lshlrev_b32 v58, 16, v23
v_and_b32 v59, 0xffff0000, v23
v_lshlrev_b32 v60, 16, v24
v_and_b32 v61, 0xffff0000, v24
v_lshlrev_b32 v62, 16, v25
v_and_b32 v63, 0xffff0000, v25
v_lshlrev_b32 v64, 16, v26
v_and_b32 v65, 0xffff0000, v26
v_lshlrev_b32 v66, 16, v27
v_and_b32 v67, 0xffff0000, v27
s_cbranch_vccnz BAR_41
s_branch BAK_42
AUR_8:
s_add_u32 s51, s51, 1
s_cmp_ge_u32 s51, 4096
s_cbranch_scc1 AUK_9
s_sleep 3
s_setprio 3
buffer_load_dword v92, v94, s[12:15], s56 offen offset:0 sc1
buffer_load_dwordx4 v[84:87], v6, s[12:15], s57 offen offset:0 sc1
buffer_load_dword v93, v94, s[12:15], s56 offen offset:256 sc1
buffer_load_dwordx4 v[88:91], v6, s[12:15], s57 offen offset:1024 sc1
s_setprio 0
s_branch AUC_7
AUR_11:
s_add_u32 s51, s51, 1
s_cmp_ge_u32 s51, 4096
s_cbranch_scc1 AUK_12
s_sleep 3
s_setprio 3
buffer_load_dword v93, v94, s[12:15], s56 offen offset:256 sc1
buffer_load_dwordx4 v[88:91], v6, s[12:15], s57 offen offset:1024 sc1
s_setprio 0
s_branch AUC_10
K_LAST:
s_endpgm
.section .rodata,"a"
.p2align 6
.amdhsa_kernel gated_mix__ssm_conv_s4d__linear_kernel_hedgehog__prompt_kernel
  .amdhsa_next_free_vgpr 256
  .amdhsa_next_free_sgpr 102
  .amdhsa_accum_offset 256
  .amdhsa_group_segment_fixed_size 0
  .amdhsa_kernarg_size 120
  .amdhsa_user_sgpr_count 2
  .amdhsa_user_sgpr_kernarg_segment_ptr 1
  .amdhsa_system_sgpr_workgroup_id_x 1
.end_amdhsa_kernel
```
